```python
import torch

def _softmax(x, axis=-1):
    return torch.softmax(x, dim=axis)
def _gelu(x):
    return torch.nn.functional.gelu(x, approximate="tanh")
def _silu(x):
    return torch.nn.functional.silu(x)
def _sigmoid(x):
    return torch.sigmoid(x)
def _layernorm(x, axis=-1, eps=1e-5):
    m = x.mean(dim=axis, keepdim=True)
    v = x.var(dim=axis, keepdim=True, unbiased=False)
    return (x - m) / torch.sqrt(v + eps)
def _scatter_add(tgt, idx, src, axis=0):
    return tgt.clone().index_add_(axis, idx, src)
def _segment_sum(src, seg, n):
    out = torch.zeros((n,) + src.shape[1:], dtype=src.dtype)
    return out.index_add_(0, seg, src)
def _pad(x, pw):
    flat = tuple(v for pair in reversed(pw) for v in pair)
    return torch.nn.functional.pad(x, flat)

kernel_name = 'concat_heads__ssm_conv_s4__linear_attn_block__prompt'

def setup_inputs():

    _w = (lambda a: (lambda t: t.to(torch.bfloat16) if t.is_floating_point() else t)(torch.as_tensor(a)))
    def _A_setup():
        B, L, D, N = 1, 2048, 512, 128
        A_re = -(lambda _x: torch.exp(torch.as_tensor(_x)))((lambda *s: torch.randn(*s, dtype=torch.bfloat16) * 6.4)(D, N))
        A_im = torch.pi * (lambda *s: torch.randn(*s, dtype=torch.bfloat16) * 0.05)(D, N)
        B_re = (lambda *s: torch.randn(*s, dtype=torch.bfloat16) * 0.1)(D, N)
        B_im = (lambda *s: torch.randn(*s, dtype=torch.bfloat16) * 0.1)(D, N)
        C_re = (lambda *s: torch.randn(*s, dtype=torch.bfloat16) * 0.1)(D, N)
        C_im = (lambda *s: torch.randn(*s, dtype=torch.bfloat16) * 0.1)(D, N)
        log_dt = (lambda *s: torch.randn(*s, dtype=torch.bfloat16) * 0.05)(D) * 0.5 - 4.0
        Dskip = (lambda *s: torch.randn(*s, dtype=torch.bfloat16) * 0.05)(D)
        return {
            "u": _w((lambda *s: torch.randn(*s, dtype=torch.bfloat16) * 0.05)(B, L, D)),
            "A_re": _w(A_re),
            "A_im": _w(A_im),
            "B_re": _w(B_re),
            "B_im": _w(B_im),
            "C_re": _w(C_re),
            "C_im": _w(C_im),
            "log_dt": _w(log_dt),
            "Dskip": _w(Dskip),
        }
    _A_in = _A_setup()

    def _B_setup():
        B, S, D = 1, 2048, 512
        return {
            "x": _w((lambda *s: torch.randn(*s, dtype=torch.bfloat16) * 0.05)(B, S, D)),
            "wqkv": _w((lambda *s: torch.randn(*s, dtype=torch.bfloat16) * 0.4)(D, 3 * D)),
            "wo": _w((lambda *s: torch.randn(*s, dtype=torch.bfloat16) * 0.05)(D, D)),
        }
    _B_in = _B_setup()

    return {
        "A_u": _A_in["u"],
        "A_A_re": _A_in["A_re"],
        "A_A_im": _A_in["A_im"],
        "A_B_re": _A_in["B_re"],
        "A_B_im": _A_in["B_im"],
        "A_C_re": _A_in["C_re"],
        "A_C_im": _A_in["C_im"],
        "A_log_dt": _A_in["log_dt"],
        "A_Dskip": _A_in["Dskip"],
        "B_x": _B_in["x"],
        "B_wqkv": _B_in["wqkv"],
        "B_wo": _B_in["wo"],
    }

def reference(A_u, A_A_re, A_A_im, A_B_re, A_B_im, A_C_re, A_C_im, A_log_dt, A_Dskip, B_x, B_wqkv, B_wo):
    def _A_ref(u, A_re, A_im, B_re, B_im, C_re, C_im, log_dt, Dskip):
        Bsz, L, D = u.shape
        dt = torch.exp(log_dt)[:, None]
        A = A_re + 1j * A_im
        Bc = B_re + 1j * B_im
        Cc = C_re + 1j * C_im
        logdA = dt * A
        dB = dt * Bc
        l = (lambda x, dt: x.to(dt))(torch.arange(L), A_re.dtype)
        P = torch.exp(logdA[:, :, None] * l[None, None, :])
        K = torch.einsum("dn,dnl,dn->dl", Cc, P, dB).real
        L2 = 2 * L
        Kp = _pad(K, ((0, 0), (0, L)))
        up = (lambda x, *d: x.permute(*d))(u, 0, 2, 1)
        up = _pad(up, ((0, 0), (0, 0), (0, L)))
        Kf = (lambda x, axes=(-2,-1): torch.fft.rfft2(x.float(), dim=axes))(Kp[:, None, :], axes=(-2, -1))
        Uf = (lambda x, axes=(-2,-1): torch.fft.rfft2(x.float(), dim=axes))(up[:, :, None, :], axes=(-2, -1))
        Yf = Uf * Kf[None, :, :, :]
        y = (lambda x, s, axes=(-2,-1): torch.fft.irfft2(x, s=s, dim=axes).to(torch.bfloat16))(Yf, (1, L2), axes=(-2, -1))[:, :, 0, :L]
        y = (lambda x, *d: x.permute(*d))(y, 0, 2, 1) + u * Dskip[None, None, :]
        return y

    def _B_ref(x, wqkv, wo):
        B, S, D = x.shape
        H = 32; Dh = D // H
        qkv = (lambda x, *d: x.permute(*d))((x @ wqkv).reshape(B, S, 3, H, Dh), 2, 0, 3, 1, 4)
        q, k, v = qkv[0], qkv[1], qkv[2]
        phi = lambda t: torch.where(t > 0, t + 1, torch.exp(t)) + 1e-6
        pq, pk = phi(q), phi(k)
        kv = torch.einsum("bhsd,bhse->bhde", pk, v)
        z = torch.einsum("bhsd->bhd", pk)
        num = torch.einsum("bhqd,bhde->bhqe", pq, kv)
        den = torch.einsum("bhqd,bhd->bhq", pq, z)[..., None] + 1e-6
        o = num / den
        return (lambda x, *d: x.permute(*d))(o, 0, 2, 1, 3).reshape(B, S, D) @ wo

    a = _A_ref(A_u, A_A_re, A_A_im, A_B_re, A_B_im, A_C_re, A_C_im, A_log_dt, A_Dskip)
    b = _B_ref(B_x, B_wqkv, B_wo)
    return torch.concatenate([a, b], axis=-1)
```

```asm
; @launch grid=(512,1,1) block=(256,1,1) lds=81920
.amdgcn_target "amdgcn-amd-amdhsa--gfx950"
.text
.globl concat_heads__ssm_conv_s4__linear_attn_block__prompt_kernel
.p2align 8
.type concat_heads__ssm_conv_s4__linear_attn_block__prompt_kernel,@function
concat_heads__ssm_conv_s4__linear_attn_block__prompt_kernel:
    s_cmp_ge_u32 s2, 512
    s_cbranch_scc1 L_end
    s_load_dwordx16 s[8:23], s[0:1], 0
    s_load_dwordx8 s[24:31], s[0:1], 64
    s_load_dwordx4 s[32:35], s[0:1], 96
    s_load_dwordx2 s[36:37], s[0:1], 112
    v_lshrrev_b32 v1, 6, v0
    s_nop 0
    v_readfirstlane_b32 s39, v1
    v_and_b32 v1, 63, v0
    s_and_b32 s3, s2, 255
    s_cmp_lt_u32 s2, 256
    s_cbranch_scc1 L_roleA
    s_setprio 3
    s_and_b32 s66, s3, 7
    s_lshr_b32 s67, s3, 3
    s_lshr_b32 s56, s66, 1
    s_lshl_b32 s56, s56, 3
    s_and_b32 s68, s67, 7
    s_add_u32 s56, s56, s68
    s_and_b32 s57, s66, 1
    s_lshl_b32 s57, s57, 2
    s_lshr_b32 s68, s67, 3
    s_add_u32 s57, s57, s68
    s_and_b32 s58, s39, 1
    s_lshr_b32 s59, s39, 1
    s_lshl_b32 s60, s39, 11
    s_mov_b32 s62, 0x3fb8aa3b
    s_mov_b32 s63, 0x3fb8aa3b
    s_mov_b32 s64, 0x358637bd
    s_mov_b32 s65, 0x358637bd
    v_lshrrev_b32 v32, 3, v1
    v_and_b32 v33, 7, v1
    v_lshrrev_b32 v34, 4, v1
    s_lshl_b32 s68, s56, 6
    s_lshl_b32 s69, s39, 4
    s_add_u32 s68, s68, s69
    v_add_u32 v35, s68, v32
    v_lshlrev_b32 v35, 10, v35
    v_xor_b32 v36, v33, v34
    v_lshl_add_u32 v2, v36, 4, v35
    v_add_u32 v37, 4, v34
    v_xor_b32 v36, v33, v37
    v_lshl_add_u32 v3, v36, 4, v35
    v_add_u32 v3, 7168, v3
    v_and_b32 v36, 1, v34
    v_lshlrev_b32 v36, 2, v36
    v_xor_b32 v36, v33, v36
    v_lshlrev_b32 v36, 4, v36
    v_add_u32 v37, s69, v32
    v_mul_u32_u24 v38, 3072, v37
    s_lshl_b32 s68, s57, 7
    v_add3_u32 v4, v38, v36, s68
    v_add_u32 v4, 1024, v4
    v_add_u32 v5, 23552, v4
    v_lshlrev_b32 v38, 10, v37
    v_add3_u32 v6, v38, v36, s68
    v_add_u32 v7, 7168, v6
    s_waitcnt lgkmcnt(0)
    s_mov_b32 s40, s26
    s_and_b32 s41, s27, 0xffff
    s_mov_b32 s42, 0x200000
    s_mov_b32 s43, 0x20000
    s_mov_b32 s44, s28
    s_and_b32 s45, s29, 0xffff
    s_mov_b32 s46, 0x180000
    s_mov_b32 s47, 0x20000
    s_mov_b32 s48, s30
    s_and_b32 s49, s31, 0xffff
    s_mov_b32 s50, 0x80000
    s_mov_b32 s51, 0x20000
    v_mov_b32 v31, 0
    s_cmp_lg_u32 s3, 0
    s_cbranch_scc1 L_b_nononce
    s_cmp_lg_u32 s39, 0
    s_cbranch_scc1 L_b_nononce
    s_memrealtime s[68:69]
    s_waitcnt lgkmcnt(0)
    s_or_b32 s68, s68, 1
    v_mov_b32 v30, s68
    s_mov_b64 exec, 1
    global_store_dword v31, v30, s[34:35] sc1
    s_mov_b64 exec, -1
L_b_nononce:
    s_mov_b32 s8, 0
    s_mov_b32 s16, 0
    s_mov_b32 s9, 196608
    s_mov_b32 s17, 128
    s_mov_b32 s10, 393216
    s_mov_b32 s18, 256
    s_mov_b32 s11, 589824
    s_mov_b32 s19, 384
    s_mov_b32 s12, 786432
    s_mov_b32 s20, 512
    s_mov_b32 s13, 983040
    s_mov_b32 s21, 640
    s_mov_b32 s14, 1179648
    s_mov_b32 s22, 768
    s_mov_b32 s15, 1376256
    s_mov_b32 s23, 896
    s_add_u32 m0, s60, 0
    s_nop 0
    buffer_load_dwordx4 v2, s[40:43], s16 offen  lds
    buffer_load_dwordx4 v3, s[40:43], s16 offen offset:1024  lds
    s_add_u32 m0, s60, 8192
    s_nop 0
    buffer_load_dwordx4 v4, s[44:47], s8 offen  lds
    buffer_load_dwordx4 v5, s[44:47], s8 offen offset:1024  lds
    s_add_u32 m0, s60, 16384
    s_nop 0
    buffer_load_dwordx4 v2, s[40:43], s17 offen  lds
    buffer_load_dwordx4 v3, s[40:43], s17 offen offset:1024  lds
    s_add_u32 m0, s60, 24576
    s_nop 0
    buffer_load_dwordx4 v4, s[44:47], s9 offen  lds
    buffer_load_dwordx4 v5, s[44:47], s9 offen offset:1024  lds
    s_add_u32 m0, s60, 32768
    s_nop 0
    buffer_load_dwordx4 v2, s[40:43], s18 offen  lds
    buffer_load_dwordx4 v3, s[40:43], s18 offen offset:1024  lds
    s_add_u32 m0, s60, 40960
    s_nop 0
    buffer_load_dwordx4 v4, s[44:47], s10 offen  lds
    buffer_load_dwordx4 v5, s[44:47], s10 offen offset:1024  lds
    s_setprio 1
    v_and_b32 v32, 31, v1
    v_lshrrev_b32 v33, 5, v1
    s_lshl_b32 s68, s58, 5
    v_add_u32 v34, s68, v32
    v_lshlrev_b32 v34, 7, v34
    v_lshrrev_b32 v35, 1, v32
    v_and_b32 v35, 7, v35
    v_add_u32 v36, 0, v33
    v_xor_b32 v36, v36, v35
    v_lshl_add_u32 v8, v36, 4, v34
    v_add_u32 v12, 40960, v8
    v_add_u32 v36, 2, v33
    v_xor_b32 v36, v36, v35
    v_lshl_add_u32 v9, v36, 4, v34
    v_add_u32 v13, 40960, v9
    v_add_u32 v36, 4, v33
    v_xor_b32 v36, v36, v35
    v_lshl_add_u32 v10, v36, 4, v34
    v_add_u32 v14, 40960, v10
    v_add_u32 v36, 6, v33
    v_xor_b32 v36, v36, v35
    v_lshl_add_u32 v11, v36, 4, v34
    v_add_u32 v15, 40960, v11
    v_lshrrev_b32 v34, 2, v1
    v_and_b32 v34, 3, v34
    v_and_b32 v35, 3, v1
    v_lshrrev_b32 v36, 4, v1
    v_and_b32 v36, 1, v36
    v_lshlrev_b32 v36, 1, v36
    v_lshrrev_b32 v37, 1, v35
    v_add_u32 v36, v36, v37
    v_lshrrev_b32 v37, 1, v34
    v_lshlrev_b32 v37, 2, v37
    v_and_b32 v38, 1, v35
    v_lshlrev_b32 v38, 3, v38
    s_lshl_b32 s68, s59, 2
    v_add_u32 v39, s68, v36
    v_xor_b32 v39, v39, v37
    v_lshl_add_u32 v39, v39, 4, v38
    v_lshl_add_u32 v40, v33, 3, v34
    v_lshl_add_u32 v16, v40, 7, v39
    v_add_u32 v17, 40960, v16
    v_xor_b32 v39, v36, v37
    v_lshl_add_u32 v39, v39, 4, v38
    v_lshl_add_u32 v40, v33, 2, v34
    v_lshl_add_u32 v18, v40, 7, v39
    s_lshl_b32 s68, s59, 15
    s_add_u32 s68, s68, 16384
    v_add_u32 v18, s68, v18
    v_xor_b32 v19, 64, v18
    s_lshl_b32 s68, s59, 1
    s_add_u32 s68, s68, s58
    s_xor_b32 s69, s68, 1
    s_lshl_b32 s66, s68, 10
    s_add_u32 s66, s66, 16384
    v_lshl_add_u32 v22, v1, 4, s66
    s_lshl_b32 s66, s69, 10
    s_add_u32 s66, s66, 16384
    v_lshl_add_u32 v23, v1, 4, s66
    s_lshl_b32 s66, s68, 8
    s_add_u32 s66, s66, 20480
    v_lshl_add_u32 v24, v1, 2, s66
    s_lshl_b32 s66, s69, 8
    s_add_u32 s66, s66, 20480
    v_lshl_add_u32 v25, v1, 2, s66
    s_lshl_b32 s68, s57, 1
    s_add_u32 s68, s68, s59
    s_lshl_b32 s68, s68, 5
    s_add_u32 s68, s68, s56
    s_mul_i32 s68, s68, 2176
    s_add_u32 s68, s68, 10551296
    s_lshl_b32 s69, s58, 10
    s_add_u32 s69, s69, s68
    v_lshl_add_u32 v26, v1, 4, s69
    v_lshrrev_b32 v40, 4, v1
    v_and_b32 v40, 1, v40
    v_lshlrev_b32 v40, 3, v40
    v_and_b32 v41, 4, v1
    v_add_u32 v40, v40, v41
    v_lshrrev_b32 v41, 2, v1
    v_and_b32 v41, 2, v41
    v_add_u32 v40, v40, v41
    v_lshrrev_b32 v41, 1, v1
    v_and_b32 v41, 1, v41
    v_add_u32 v40, v40, v41
    s_add_u32 s68, s68, 2048
    v_lshl_add_u32 v27, v40, 3, s68
    s_lshl_b32 s68, s56, 1
    s_add_u32 s68, s68, s58
    s_lshl_b32 s68, s68, 5
    s_lshl_b32 s69, s57, 2
    s_add_u32 s68, s68, s69
    s_lshl_b32 s69, s59, 1
    s_add_u32 s68, s68, s69
    s_lshl_b32 s68, s68, 10
    s_add_u32 s68, s68, 8388608
    v_lshl_add_u32 v28, v1, 4, s68
    v_and_b32 v40, 16, v1
    v_cmp_ne_u32 s[52:53], 0, v40
    s_sub_u32 s54, 0, s58
    s_mov_b32 s55, s54
    s_cmp_lg_u32 s39, 3
    s_cbranch_scc1 L_b_nopt
    s_lshl_b32 s68, s56, 7
    s_add_u32 s68, s68, 10485760
    v_mov_b32 v40, s68
    global_load_dword v21, v40, s[36:37] sc1
L_b_nopt:
    v_mov_b32 v80, s64
    v_mov_b32 v81, s64
    v_mov_b32 v82, s64
    v_mov_b32 v83, s64
    v_mov_b32 v84, s64
    v_mov_b32 v85, s64
    v_mov_b32 v86, s64
    v_mov_b32 v87, s64
    v_mov_b32 v88, s64
    v_mov_b32 v89, s64
    v_mov_b32 v90, s64
    v_mov_b32 v91, s64
    v_mov_b32 v92, s64
    v_mov_b32 v93, s64
    v_mov_b32 v94, s64
    v_mov_b32 v95, s64
    v_mov_b32 v96, s64
    v_mov_b32 v97, s64
    v_mov_b32 v98, s64
    v_mov_b32 v99, s64
    v_mov_b32 v100, s64
    v_mov_b32 v101, s64
    v_mov_b32 v102, s64
    v_mov_b32 v103, s64
    v_mov_b32 v104, s64
    v_mov_b32 v105, s64
    v_mov_b32 v106, s64
    v_mov_b32 v107, s64
    v_mov_b32 v108, s64
    v_mov_b32 v109, s64
    v_mov_b32 v110, s64
    v_mov_b32 v111, s64
    s_waitcnt vmcnt(8)
    s_barrier
    ds_read_b128 v[128:131], v8 offset:0
    ds_read_b64_tr_b16 v[32:33], v16 offset:8192
    ds_read_b64_tr_b16 v[34:35], v16 offset:8704
    ds_read_b128 v[132:135], v9 offset:0
    ds_read_b64_tr_b16 v[36:37], v16 offset:10240
    ds_read_b64_tr_b16 v[38:39], v16 offset:10752
    ds_read_b128 v[136:139], v10 offset:0
    ds_read_b64_tr_b16 v[40:41], v16 offset:12288
    ds_read_b64_tr_b16 v[42:43], v16 offset:12800
    ds_read_b128 v[140:143], v11 offset:0
    ds_read_b64_tr_b16 v[44:45], v16 offset:14336
    ds_read_b64_tr_b16 v[46:47], v16 offset:14848
    s_waitcnt vmcnt(4)
    s_barrier
    s_waitcnt lgkmcnt(6)
    v_mfma_f32_32x32x16_bf16 v[96:111], v[128:131], v[32:35], v[96:111]
    s_add_u32 m0, s60, 49152
    ds_read_b128 v[144:147], v8 offset:16384
    ds_read_b64_tr_b16 v[48:49], v16 offset:24576
    ds_read_b64_tr_b16 v[50:51], v16 offset:25088
    buffer_load_dwordx4 v2, s[40:43], s19 offen  lds
    buffer_load_dwordx4 v3, s[40:43], s19 offen offset:1024  lds
    v_mfma_f32_32x32x16_bf16 v[96:111], v[132:135], v[36:39], v[96:111]
    s_add_u32 m0, s60, 57344
    ds_read_b128 v[148:151], v9 offset:16384
    ds_read_b64_tr_b16 v[52:53], v16 offset:26624
    ds_read_b64_tr_b16 v[54:55], v16 offset:27136
    buffer_load_dwordx4 v4, s[44:47], s11 offen  lds
    buffer_load_dwordx4 v5, s[44:47], s11 offen offset:1024  lds
    s_waitcnt lgkmcnt(6)
    v_mfma_f32_32x32x16_bf16 v[96:111], v[136:139], v[40:43], v[96:111]
    s_add_u32 m0, s60, 65536
    ds_read_b128 v[152:155], v10 offset:16384
    ds_read_b64_tr_b16 v[56:57], v16 offset:28672
    ds_read_b64_tr_b16 v[58:59], v16 offset:29184
    buffer_load_dwordx4 v2, s[40:43], s20 offen  lds
    buffer_load_dwordx4 v3, s[40:43], s20 offen offset:1024  lds
    v_mfma_f32_32x32x16_bf16 v[96:111], v[140:143], v[44:47], v[96:111]
    s_add_u32 m0, s60, 73728
    ds_read_b128 v[156:159], v11 offset:16384
    ds_read_b64_tr_b16 v[60:61], v16 offset:30720
    ds_read_b64_tr_b16 v[62:63], v16 offset:31232
    buffer_load_dwordx4 v4, s[44:47], s12 offen  lds
    buffer_load_dwordx4 v5, s[44:47], s12 offen offset:1024  lds
    s_waitcnt vmcnt(8)
    s_barrier
    s_waitcnt lgkmcnt(6)
    v_mfma_f32_32x32x16_bf16 v[96:111], v[144:147], v[48:51], v[96:111]
    s_add_u32 m0, s60, 0
    ds_read_b128 v[160:163], v8 offset:32768
    ds_read_b64_tr_b16 v[32:33], v17 offset:0
    ds_read_b64_tr_b16 v[34:35], v17 offset:512
    buffer_load_dwordx4 v2, s[40:43], s21 offen  lds
    v_mfma_f32_32x32x16_bf16 v[96:111], v[148:151], v[52:55], v[96:111]
    ds_read_b128 v[164:167], v9 offset:32768
    ds_read_b64_tr_b16 v[36:37], v17 offset:2048
    ds_read_b64_tr_b16 v[38:39], v17 offset:2560
    buffer_load_dwordx4 v3, s[40:43], s21 offen offset:1024  lds
    s_waitcnt lgkmcnt(6)
    v_mfma_f32_32x32x16_bf16 v[96:111], v[152:155], v[56:59], v[96:111]
    s_add_u32 m0, s60, 8192
    ds_read_b128 v[168:171], v10 offset:32768
    ds_read_b64_tr_b16 v[40:41], v17 offset:4096
    ds_read_b64_tr_b16 v[42:43], v17 offset:4608
    buffer_load_dwordx4 v4, s[44:47], s13 offen  lds
    v_mfma_f32_32x32x16_bf16 v[96:111], v[156:159], v[60:63], v[96:111]
    ds_read_b128 v[172:175], v11 offset:32768
    ds_read_b64_tr_b16 v[44:45], v17 offset:6144
    ds_read_b64_tr_b16 v[46:47], v17 offset:6656
    buffer_load_dwordx4 v5, s[44:47], s13 offen offset:1024  lds
    s_waitcnt vmcnt(8)
    s_barrier
    s_waitcnt lgkmcnt(6)
    v_mfma_f32_32x32x16_bf16 v[96:111], v[160:163], v[32:35], v[96:111]
    s_add_u32 m0, s60, 16384
    ds_read_b128 v[176:179], v12 offset:8192
    ds_read_b64_tr_b16 v[48:49], v17 offset:16384
    ds_read_b64_tr_b16 v[50:51], v17 offset:16896
    buffer_load_dwordx4 v2, s[40:43], s22 offen  lds
    v_mfma_f32_32x32x16_bf16 v[96:111], v[164:167], v[36:39], v[96:111]
    ds_read_b128 v[180:183], v13 offset:8192
    ds_read_b64_tr_b16 v[52:53], v17 offset:18432
    ds_read_b64_tr_b16 v[54:55], v17 offset:18944
    buffer_load_dwordx4 v3, s[40:43], s22 offen offset:1024  lds
    s_waitcnt lgkmcnt(6)
    v_mfma_f32_32x32x16_bf16 v[96:111], v[168:171], v[40:43], v[96:111]
    s_add_u32 m0, s60, 24576
    ds_read_b128 v[184:187], v14 offset:8192
    ds_read_b64_tr_b16 v[56:57], v17 offset:20480
    ds_read_b64_tr_b16 v[58:59], v17 offset:20992
    buffer_load_dwordx4 v4, s[44:47], s14 offen  lds
    v_mfma_f32_32x32x16_bf16 v[96:111], v[172:175], v[44:47], v[96:111]
    ds_read_b128 v[188:191], v15 offset:8192
    ds_read_b64_tr_b16 v[60:61], v17 offset:22528
    ds_read_b64_tr_b16 v[62:63], v17 offset:23040
    buffer_load_dwordx4 v5, s[44:47], s14 offen offset:1024  lds
    s_waitcnt vmcnt(8)
    s_barrier
    s_waitcnt lgkmcnt(6)
    v_mfma_f32_32x32x16_bf16 v[96:111], v[176:179], v[48:51], v[96:111]
    s_add_u32 m0, s60, 32768
    ds_read_b128 v[192:195], v12 offset:24576
    ds_read_b64_tr_b16 v[32:33], v17 offset:32768
    ds_read_b64_tr_b16 v[34:35], v17 offset:33280
    buffer_load_dwordx4 v2, s[40:43], s23 offen  lds
    v_mfma_f32_32x32x16_bf16 v[96:111], v[180:183], v[52:55], v[96:111]
    ds_read_b128 v[196:199], v13 offset:24576
    ds_read_b64_tr_b16 v[36:37], v17 offset:34816
    ds_read_b64_tr_b16 v[38:39], v17 offset:35328
    buffer_load_dwordx4 v3, s[40:43], s23 offen offset:1024  lds
    s_waitcnt lgkmcnt(6)
    v_mfma_f32_32x32x16_bf16 v[96:111], v[184:187], v[56:59], v[96:111]
    s_add_u32 m0, s60, 40960
    ds_read_b128 v[200:203], v14 offset:24576
    ds_read_b64_tr_b16 v[40:41], v17 offset:36864
    ds_read_b64_tr_b16 v[42:43], v17 offset:37376
    buffer_load_dwordx4 v4, s[44:47], s15 offen  lds
    v_mfma_f32_32x32x16_bf16 v[96:111], v[188:191], v[60:63], v[96:111]
    ds_read_b128 v[204:207], v15 offset:24576
    ds_read_b64_tr_b16 v[44:45], v17 offset:38912
    ds_read_b64_tr_b16 v[46:47], v17 offset:39424
    buffer_load_dwordx4 v5, s[44:47], s15 offen offset:1024  lds
    s_waitcnt vmcnt(8)
    s_barrier
    s_waitcnt lgkmcnt(6)
    v_mfma_f32_32x32x16_bf16 v[96:111], v[192:195], v[32:35], v[96:111]
    v_add_u32 v4, 1024, v4
    v_add_u32 v5, 1024, v5
    s_add_u32 m0, s60, 49152
    ds_read_b128 v[208:211], v8 offset:0
    ds_read_b64_tr_b16 v[48:49], v16 offset:8192
    ds_read_b64_tr_b16 v[50:51], v16 offset:8704
    buffer_load_dwordx4 v4, s[44:47], s8 offen  lds
    v_mfma_f32_32x32x16_bf16 v[96:111], v[196:199], v[36:39], v[96:111]
    ds_read_b128 v[212:215], v9 offset:0
    ds_read_b64_tr_b16 v[52:53], v16 offset:10240
    ds_read_b64_tr_b16 v[54:55], v16 offset:10752
    buffer_load_dwordx4 v5, s[44:47], s8 offen offset:1024  lds
    s_waitcnt lgkmcnt(6)
    v_mfma_f32_32x32x16_bf16 v[96:111], v[200:203], v[40:43], v[96:111]
    s_add_u32 m0, s60, 57344
    ds_read_b128 v[216:219], v10 offset:0
    ds_read_b64_tr_b16 v[56:57], v16 offset:12288
    ds_read_b64_tr_b16 v[58:59], v16 offset:12800
    buffer_load_dwordx4 v4, s[44:47], s9 offen  lds
    v_mfma_f32_32x32x16_bf16 v[96:111], v[204:207], v[44:47], v[96:111]
    ds_read_b128 v[220:223], v11 offset:0
    ds_read_b64_tr_b16 v[60:61], v16 offset:14336
    ds_read_b64_tr_b16 v[62:63], v16 offset:14848
    buffer_load_dwordx4 v5, s[44:47], s9 offen offset:1024  lds
    s_waitcnt vmcnt(8)
    s_barrier
    s_waitcnt lgkmcnt(6)
    v_mfma_f32_32x32x16_bf16 v[96:111], v[208:211], v[48:51], v[96:111]
    s_add_u32 m0, s60, 65536
    ds_read_b128 v[224:227], v8 offset:16384
    ds_read_b64_tr_b16 v[32:33], v16 offset:24576
    ds_read_b64_tr_b16 v[34:35], v16 offset:25088
    buffer_load_dwordx4 v4, s[44:47], s10 offen  lds
    v_mfma_f32_32x32x16_bf16 v[96:111], v[212:215], v[52:55], v[96:111]
    ds_read_b128 v[228:231], v9 offset:16384
    ds_read_b64_tr_b16 v[36:37], v16 offset:26624
    ds_read_b64_tr_b16 v[38:39], v16 offset:27136
    buffer_load_dwordx4 v5, s[44:47], s10 offen offset:1024  lds
    s_waitcnt lgkmcnt(6)
    v_mfma_f32_32x32x16_bf16 v[96:111], v[216:219], v[56:59], v[96:111]
    s_add_u32 m0, s60, 73728
    ds_read_b128 v[232:235], v10 offset:16384
    ds_read_b64_tr_b16 v[40:41], v16 offset:28672
    ds_read_b64_tr_b16 v[42:43], v16 offset:29184
    buffer_load_dwordx4 v4, s[44:47], s11 offen  lds
    v_mfma_f32_32x32x16_bf16 v[96:111], v[220:223], v[60:63], v[96:111]
    ds_read_b128 v[236:239], v11 offset:16384
    ds_read_b64_tr_b16 v[44:45], v16 offset:30720
    ds_read_b64_tr_b16 v[46:47], v16 offset:31232
    buffer_load_dwordx4 v5, s[44:47], s11 offen offset:1024  lds
    s_waitcnt vmcnt(8)
    s_barrier
    s_waitcnt lgkmcnt(6)
    v_mfma_f32_32x32x16_bf16 v[96:111], v[224:227], v[32:35], v[96:111]
    s_add_u32 m0, s60, 0
    ds_read_b128 v[240:243], v8 offset:32768
    ds_read_b64_tr_b16 v[48:49], v17 offset:0
    ds_read_b64_tr_b16 v[50:51], v17 offset:512
    buffer_load_dwordx4 v4, s[44:47], s12 offen  lds
    v_mfma_f32_32x32x16_bf16 v[96:111], v[228:231], v[36:39], v[96:111]
    ds_read_b128 v[244:247], v9 offset:32768
    ds_read_b64_tr_b16 v[52:53], v17 offset:2048
    ds_read_b64_tr_b16 v[54:55], v17 offset:2560
    buffer_load_dwordx4 v5, s[44:47], s12 offen offset:1024  lds
    s_waitcnt lgkmcnt(6)
    v_mfma_f32_32x32x16_bf16 v[96:111], v[232:235], v[40:43], v[96:111]
    s_add_u32 m0, s60, 8192
    ds_read_b128 v[248:251], v10 offset:32768
    ds_read_b64_tr_b16 v[56:57], v17 offset:4096
    ds_read_b64_tr_b16 v[58:59], v17 offset:4608
    buffer_load_dwordx4 v4, s[44:47], s13 offen  lds
    v_mfma_f32_32x32x16_bf16 v[96:111], v[236:239], v[44:47], v[96:111]
    ds_read_b128 v[252:255], v11 offset:32768
    ds_read_b64_tr_b16 v[60:61], v17 offset:6144
    ds_read_b64_tr_b16 v[62:63], v17 offset:6656
    buffer_load_dwordx4 v5, s[44:47], s13 offen offset:1024  lds
    s_waitcnt vmcnt(8)
    s_barrier
    s_waitcnt lgkmcnt(6)
    v_mfma_f32_32x32x16_bf16 v[96:111], v[240:243], v[48:51], v[96:111]
    s_add_u32 m0, s60, 16384
    ds_read_b64_tr_b16 v[32:33], v17 offset:8192
    ds_read_b64_tr_b16 v[34:35], v17 offset:8704
    ds_read_b64_tr_b16 v[48:49], v17 offset:16384
    ds_read_b64_tr_b16 v[50:51], v17 offset:16896
    buffer_load_dwordx4 v4, s[44:47], s14 offen  lds
    v_mfma_f32_32x32x16_bf16 v[96:111], v[244:247], v[52:55], v[96:111]
    ds_read_b64_tr_b16 v[36:37], v17 offset:10240
    ds_read_b64_tr_b16 v[38:39], v17 offset:10752
    ds_read_b64_tr_b16 v[52:53], v17 offset:18432
    ds_read_b64_tr_b16 v[54:55], v17 offset:18944
    buffer_load_dwordx4 v5, s[44:47], s14 offen offset:1024  lds
    s_waitcnt lgkmcnt(8)
    v_mfma_f32_32x32x16_bf16 v[96:111], v[248:251], v[56:59], v[96:111]
    s_add_u32 m0, s60, 24576
    ds_read_b64_tr_b16 v[40:41], v17 offset:12288
    ds_read_b64_tr_b16 v[42:43], v17 offset:12800
    ds_read_b64_tr_b16 v[56:57], v17 offset:20480
    ds_read_b64_tr_b16 v[58:59], v17 offset:20992
    buffer_load_dwordx4 v4, s[44:47], s15 offen  lds
    v_mfma_f32_32x32x16_bf16 v[96:111], v[252:255], v[60:63], v[96:111]
    ds_read_b64_tr_b16 v[44:45], v17 offset:14336
    ds_read_b64_tr_b16 v[46:47], v17 offset:14848
    ds_read_b64_tr_b16 v[60:61], v17 offset:22528
    ds_read_b64_tr_b16 v[62:63], v17 offset:23040
    buffer_load_dwordx4 v5, s[44:47], s15 offen offset:1024  lds
    global_load_dword v21, v31, s[34:35] sc1
    s_waitcnt vmcnt(9)
    s_barrier
    s_waitcnt lgkmcnt(10)
    v_mfma_f32_32x32x16_bf16 v[112:127], v[128:131], v[32:35], 0
    ds_read_b64_tr_b16 v[32:33], v17 offset:24576
    ds_read_b64_tr_b16 v[34:35], v17 offset:25088
    v_mfma_f32_32x32x16_bf16 v[112:127], v[132:135], v[36:39], v[112:127]
    v_subrev_u32 v4, 2048, v4
    v_subrev_u32 v5, 2048, v5
    s_add_u32 m0, s60, 32768
    ds_read_b64_tr_b16 v[36:37], v17 offset:26624
    ds_read_b64_tr_b16 v[38:39], v17 offset:27136
    buffer_load_dwordx4 v4, s[44:47], s8 offen  lds
    v_mul_f32 v64, s62, v96
    v_mul_f32 v65, s62, v97
    v_mul_f32 v66, s62, v98
    s_waitcnt lgkmcnt(6)
    v_mfma_f32_32x32x16_bf16 v[112:127], v[136:139], v[40:43], v[112:127]
    ds_read_b64_tr_b16 v[40:41], v17 offset:28672
    ds_read_b64_tr_b16 v[42:43], v17 offset:29184
    v_mul_f32 v67, s62, v99
    v_mul_f32 v68, s62, v100
    v_mul_f32 v69, s62, v101
    v_mfma_f32_32x32x16_bf16 v[112:127], v[140:143], v[44:47], v[112:127]
    ds_read_b64_tr_b16 v[44:45], v17 offset:30720
    ds_read_b64_tr_b16 v[46:47], v17 offset:31232
    buffer_load_dwordx4 v5, s[44:47], s8 offen offset:1024  lds
    v_mul_f32 v70, s62, v102
    v_mul_f32 v71, s62, v103
    v_mul_f32 v72, s62, v104
    v_mfma_f32_32x32x16_bf16 v[112:127], v[144:147], v[48:51], v[112:127]
    ds_read_b64_tr_b16 v[48:49], v17 offset:32768
    ds_read_b64_tr_b16 v[50:51], v17 offset:33280
    v_mul_f32 v73, s62, v105
    v_mul_f32 v74, s62, v106
    v_mul_f32 v75, s62, v107
    v_mfma_f32_32x32x16_bf16 v[112:127], v[148:151], v[52:55], v[112:127]
    s_add_u32 m0, s60, 40960
    ds_read_b64_tr_b16 v[52:53], v17 offset:34816
    ds_read_b64_tr_b16 v[54:55], v17 offset:35328
    buffer_load_dwordx4 v4, s[44:47], s9 offen  lds
    v_mul_f32 v76, s62, v108
    v_mul_f32 v77, s62, v109
    v_mul_f32 v78, s62, v110
    s_waitcnt lgkmcnt(12)
    v_mfma_f32_32x32x16_bf16 v[112:127], v[152:155], v[56:59], v[112:127]
    ds_read_b64_tr_b16 v[56:57], v17 offset:36864
    ds_read_b64_tr_b16 v[58:59], v17 offset:37376
    v_mul_f32 v79, s62, v111
    v_exp_f32 v64, v64 clamp
    v_max_f32 v96, s64, v96
    v_mfma_f32_32x32x16_bf16 v[112:127], v[156:159], v[60:63], v[112:127]
    ds_read_b64_tr_b16 v[60:61], v17 offset:38912
    ds_read_b64_tr_b16 v[62:63], v17 offset:39424
    buffer_load_dwordx4 v5, s[44:47], s9 offen offset:1024  lds
    v_exp_f32 v65, v65 clamp
    v_max_f32 v97, s64, v97
    v_exp_f32 v66, v66 clamp
    s_waitcnt vmcnt(9)
    s_barrier
    s_waitcnt lgkmcnt(12)
    v_mfma_f32_32x32x16_bf16 v[112:127], v[160:163], v[32:35], v[112:127]
    ds_read_b64_tr_b16 v[32:33], v16 offset:0
    ds_read_b64_tr_b16 v[34:35], v16 offset:512
    v_max_f32 v98, s64, v98
    v_exp_f32 v67, v67 clamp
    v_max_f32 v99, s64, v99
    v_mfma_f32_32x32x16_bf16 v[112:127], v[164:167], v[36:39], v[112:127]
    s_add_u32 m0, s60, 49152
    ds_read_b64_tr_b16 v[36:37], v16 offset:2048
    ds_read_b64_tr_b16 v[38:39], v16 offset:2560
    buffer_load_dwordx4 v4, s[44:47], s10 offen  lds
    v_exp_f32 v68, v68 clamp
    v_max_f32 v100, s64, v100
    v_exp_f32 v69, v69 clamp
    s_waitcnt lgkmcnt(12)
    v_mfma_f32_32x32x16_bf16 v[112:127], v[168:171], v[40:43], v[112:127]
    ds_read_b64_tr_b16 v[40:41], v16 offset:4096
    ds_read_b64_tr_b16 v[42:43], v16 offset:4608
    v_max_f32 v101, s64, v101
    v_exp_f32 v70, v70 clamp
    v_max_f32 v102, s64, v102
    v_mfma_f32_32x32x16_bf16 v[112:127], v[172:175], v[44:47], v[112:127]
    ds_read_b64_tr_b16 v[44:45], v16 offset:6144
    ds_read_b64_tr_b16 v[46:47], v16 offset:6656
    buffer_load_dwordx4 v5, s[44:47], s10 offen offset:1024  lds
    v_exp_f32 v71, v71 clamp
    v_max_f32 v103, s64, v103
    v_exp_f32 v72, v72 clamp
    s_waitcnt lgkmcnt(12)
    v_mfma_f32_32x32x16_bf16 v[112:127], v[176:179], v[48:51], v[112:127]
    ds_read_b64_tr_b16 v[48:49], v16 offset:8192
    ds_read_b64_tr_b16 v[50:51], v16 offset:8704
    v_max_f32 v104, s64, v104
    v_exp_f32 v73, v73 clamp
    v_max_f32 v105, s64, v105
    v_mfma_f32_32x32x16_bf16 v[112:127], v[180:183], v[52:55], v[112:127]
    s_add_u32 m0, s60, 57344
    ds_read_b64_tr_b16 v[52:53], v16 offset:10240
    ds_read_b64_tr_b16 v[54:55], v16 offset:10752
    buffer_load_dwordx4 v4, s[44:47], s11 offen  lds
    v_exp_f32 v74, v74 clamp
    v_max_f32 v106, s64, v106
    v_exp_f32 v75, v75 clamp
    s_waitcnt lgkmcnt(12)
    v_mfma_f32_32x32x16_bf16 v[112:127], v[184:187], v[56:59], v[112:127]
    ds_read_b64_tr_b16 v[56:57], v16 offset:12288
    ds_read_b64_tr_b16 v[58:59], v16 offset:12800
    v_max_f32 v107, s64, v107
    v_exp_f32 v76, v76 clamp
    v_max_f32 v108, s64, v108
    v_mfma_f32_32x32x16_bf16 v[112:127], v[188:191], v[60:63], v[112:127]
    ds_read_b64_tr_b16 v[60:61], v16 offset:14336
    ds_read_b64_tr_b16 v[62:63], v16 offset:14848
    buffer_load_dwordx4 v5, s[44:47], s11 offen offset:1024  lds
    v_exp_f32 v77, v77 clamp
    v_max_f32 v109, s64, v109
    v_exp_f32 v78, v78 clamp
    s_lshl_b32 s68, s56, 7
    s_add_u32 s68, s68, 10485760
    v_and_b32 v2, 7, v1
    v_lshl_add_u32 v2, v2, 2, s68
    s_waitcnt vmcnt(9)
    s_barrier
    s_waitcnt lgkmcnt(12)
    v_mfma_f32_32x32x16_bf16 v[112:127], v[192:195], v[32:35], v[112:127]
    ds_read_b64_tr_b16 v[32:33], v16 offset:16384
    ds_read_b64_tr_b16 v[34:35], v16 offset:16896
    v_max_f32 v110, s64, v110
    v_exp_f32 v79, v79 clamp
    v_max_f32 v111, s64, v111
    v_mfma_f32_32x32x16_bf16 v[112:127], v[196:199], v[36:39], v[112:127]
    s_add_u32 m0, s60, 65536
    ds_read_b64_tr_b16 v[36:37], v16 offset:18432
    ds_read_b64_tr_b16 v[38:39], v16 offset:18944
    buffer_load_dwordx4 v4, s[44:47], s12 offen  lds
    v_add_f32 v96, v96, v64
    v_add_f32 v97, v97, v65
    v_add_f32 v98, v98, v66
    s_waitcnt lgkmcnt(12)
    v_mfma_f32_32x32x16_bf16 v[112:127], v[200:203], v[40:43], v[112:127]
    ds_read_b64_tr_b16 v[40:41], v16 offset:20480
    ds_read_b64_tr_b16 v[42:43], v16 offset:20992
    v_add_f32 v99, v99, v67
    v_add_f32 v100, v100, v68
    v_add_f32 v101, v101, v69
    v_mfma_f32_32x32x16_bf16 v[112:127], v[204:207], v[44:47], v[112:127]
    ds_read_b64_tr_b16 v[44:45], v16 offset:22528
    ds_read_b64_tr_b16 v[46:47], v16 offset:23040
    buffer_load_dwordx4 v5, s[44:47], s12 offen offset:1024  lds
    v_add_f32 v102, v102, v70
    v_add_f32 v103, v103, v71
    v_add_f32 v104, v104, v72
    s_waitcnt lgkmcnt(12)
    v_mfma_f32_32x32x16_bf16 v[112:127], v[208:211], v[48:51], v[112:127]
    ds_read_b64_tr_b16 v[48:49], v16 offset:24576
    ds_read_b64_tr_b16 v[50:51], v16 offset:25088
    v_add_f32 v105, v105, v73
    v_add_f32 v106, v106, v74
    v_add_f32 v107, v107, v75
    v_mfma_f32_32x32x16_bf16 v[112:127], v[212:215], v[52:55], v[112:127]
    s_add_u32 m0, s60, 73728
    ds_read_b64_tr_b16 v[52:53], v16 offset:26624
    ds_read_b64_tr_b16 v[54:55], v16 offset:27136
    buffer_load_dwordx4 v4, s[44:47], s13 offen  lds
    v_add_f32 v108, v108, v76
    v_add_f32 v109, v109, v77
    v_add_f32 v110, v110, v78
    s_waitcnt lgkmcnt(12)
    v_mfma_f32_32x32x16_bf16 v[112:127], v[216:219], v[56:59], v[112:127]
    ds_read_b64_tr_b16 v[56:57], v16 offset:28672
    ds_read_b64_tr_b16 v[58:59], v16 offset:29184
    v_add_f32 v111, v111, v79
    v_add_f32 v64, v96, v97
    v_add_f32 v65, v98, v99
    v_mfma_f32_32x32x16_bf16 v[112:127], v[220:223], v[60:63], v[112:127]
    ds_read_b64_tr_b16 v[60:61], v16 offset:30720
    ds_read_b64_tr_b16 v[62:63], v16 offset:31232
    buffer_load_dwordx4 v5, s[44:47], s13 offen offset:1024  lds
    v_add_f32 v66, v100, v101
    v_add_f32 v67, v102, v103
    v_add_f32 v68, v104, v105
    s_waitcnt vmcnt(12)
    v_readfirstlane_b32 s38, v21
    s_nop 0
    s_cmp_lg_u32 s38, 0
    s_cbranch_scc1 L_nonce_ok_2
    s_mov_b32 s61, 0
L_nonce_1:
    global_load_dword v21, v31, s[34:35] sc1
    s_waitcnt vmcnt(0)
    v_readfirstlane_b32 s38, v21
    s_add_u32 s61, s61, 1
    s_cmp_gt_u32 s61, 200000
    s_cbranch_scc1 L_nonce_ok_2
    s_cmp_eq_u32 s38, 0
    s_cbranch_scc1 L_nonce_1
L_nonce_ok_2:
    s_waitcnt vmcnt(8)
    s_barrier
    s_waitcnt lgkmcnt(12)
    v_mfma_f32_32x32x16_bf16 v[112:127], v[224:227], v[32:35], v[112:127]
    ds_read_b64_tr_b16 v[32:33], v16 offset:32768
    ds_read_b64_tr_b16 v[34:35], v16 offset:33280
    v_add_f32 v69, v106, v107
    v_add_f32 v70, v108, v109
    v_add_f32 v71, v110, v111
    v_mfma_f32_32x32x16_bf16 v[112:127], v[228:231], v[36:39], v[112:127]
    s_add_u32 m0, s60, 0
    ds_read_b64_tr_b16 v[36:37], v16 offset:34816
    ds_read_b64_tr_b16 v[38:39], v16 offset:35328
    buffer_load_dwordx4 v4, s[44:47], s14 offen  lds
    v_add_f32 v64, v64, v68
    v_add_f32 v65, v65, v69
    v_add_f32 v66, v66, v70
    s_waitcnt lgkmcnt(12)
    v_mfma_f32_32x32x16_bf16 v[112:127], v[232:235], v[40:43], v[112:127]
    ds_read_b64_tr_b16 v[40:41], v16 offset:36864
    ds_read_b64_tr_b16 v[42:43], v16 offset:37376
    v_add_f32 v67, v67, v71
    v_add_f32 v64, v64, v66
    v_add_f32 v65, v65, v67
    v_mfma_f32_32x32x16_bf16 v[112:127], v[236:239], v[44:47], v[112:127]
    ds_read_b64_tr_b16 v[44:45], v16 offset:38912
    ds_read_b64_tr_b16 v[46:47], v16 offset:39424
    buffer_load_dwordx4 v5, s[44:47], s14 offen offset:1024  lds
    v_add_f32 v29, v64, v65
    v_cvt_pk_bf16_f32 v96, v96, v97
    v_cvt_pk_bf16_f32 v97, v98, v99
    s_waitcnt lgkmcnt(12)
    v_mfma_f32_32x32x16_bf16 v[112:127], v[240:243], v[48:51], v[112:127]
    ds_read_b64_tr_b16 v[48:49], v17 offset:0
    ds_read_b64_tr_b16 v[50:51], v17 offset:512
    v_cvt_pk_bf16_f32 v98, v100, v101
    v_cvt_pk_bf16_f32 v99, v102, v103
    v_cvt_pk_bf16_f32 v100, v104, v105
    v_mfma_f32_32x32x16_bf16 v[112:127], v[244:247], v[52:55], v[112:127]
    s_add_u32 m0, s60, 8192
    ds_read_b64_tr_b16 v[52:53], v17 offset:2048
    ds_read_b64_tr_b16 v[54:55], v17 offset:2560
    buffer_load_dwordx4 v4, s[44:47], s15 offen  lds
    v_cvt_pk_bf16_f32 v101, v106, v107
    v_cvt_pk_bf16_f32 v102, v108, v109
    v_cvt_pk_bf16_f32 v103, v110, v111
    s_waitcnt lgkmcnt(12)
    v_mfma_f32_32x32x16_bf16 v[112:127], v[248:251], v[56:59], v[112:127]
    ds_read_b64_tr_b16 v[56:57], v17 offset:4096
    ds_read_b64_tr_b16 v[58:59], v17 offset:4608
    v_mov_b32 v30, v29
    s_nop 1
    v_permlane32_swap_b32 v29, v30
    v_add_f32 v29, v29, v30
    v_mfma_f32_32x32x16_bf16 v[112:127], v[252:255], v[60:63], v[112:127]
    ds_read_b64_tr_b16 v[60:61], v17 offset:6144
    ds_read_b64_tr_b16 v[62:63], v17 offset:6656
    buffer_load_dwordx4 v5, s[44:47], s15 offen offset:1024  lds
    s_barrier
    s_nop 7
    v_cvt_pk_bf16_f32 v112, v112, v113
    v_cvt_pk_bf16_f32 v113, v114, v115
    v_cvt_pk_bf16_f32 v114, v116, v117
    v_cvt_pk_bf16_f32 v115, v118, v119
    v_cvt_pk_bf16_f32 v116, v120, v121
    v_cvt_pk_bf16_f32 v117, v122, v123
    v_cvt_pk_bf16_f32 v118, v124, v125
    v_cvt_pk_bf16_f32 v119, v126, v127
    v_mfma_f32_32x32x16_bf16 v[64:79], v[96:99], v[112:115], 0
    s_nop 0
    v_mfma_f32_32x32x16_bf16 v[64:79], v[100:103], v[116:119], v[64:79]
    ds_write_b32 v24, v29
    s_nop 10
    v_cndmask_b32 v104, v64, v72, s[52:53]
    v_cndmask_b32 v105, v65, v73, s[52:53]
    v_cndmask_b32 v106, v66, v74, s[52:53]
    v_cndmask_b32 v107, v67, v75, s[52:53]
    v_cndmask_b32 v108, v68, v76, s[52:53]
    v_cndmask_b32 v109, v69, v77, s[52:53]
    v_cndmask_b32 v110, v70, v78, s[52:53]
    v_cndmask_b32 v111, v71, v79, s[52:53]
    v_cndmask_b32 v120, v108, v104, s[54:55]
    v_cndmask_b32 v121, v109, v105, s[54:55]
    v_cndmask_b32 v122, v110, v106, s[54:55]
    v_cndmask_b32 v123, v111, v107, s[54:55]
    ds_write_b128 v22, v[120:123]
    v_cndmask_b32 v124, v104, v108, s[54:55]
    v_cndmask_b32 v125, v105, v109, s[54:55]
    v_cndmask_b32 v126, v106, v110, s[54:55]
    v_cndmask_b32 v127, v107, v111, s[54:55]
    s_waitcnt lgkmcnt(0)
    s_barrier
    ds_read_b128 v[104:107], v23
    ds_read_b32 v30, v25
    s_waitcnt lgkmcnt(0)
    v_add_f32 v124, v124, v104
    v_add_f32 v125, v125, v105
    v_add_f32 v126, v126, v106
    v_add_f32 v127, v127, v107
    v_add_f32 v29, v29, v30
    v_cvt_pk_bf16_f32 v104, v124, v125
    v_mov_b32 v105, s38
    v_cvt_pk_bf16_f32 v106, v126, v127
    v_mov_b32 v107, s38
    v_mov_b32_dpp v30, v29 quad_perm:[1,0,3,2] row_mask:0xf bank_mask:0xf
    global_store_dwordx4 v26, v[104:107], s[36:37] sc1
    v_cvt_pk_bf16_f32 v108, v29, v30
    v_mov_b32 v109, s38
    s_andn2_b64 exec, 0x55555555, s[54:55]
    s_cbranch_execz L_b_noz
    global_store_dwordx2 v27, v[108:109], s[36:37] sc1
L_b_noz:
    s_mov_b64 exec, -1
    s_waitcnt vmcnt(9)
    s_barrier
    v_mfma_f32_32x32x16_bf16 v[80:95], v[32:35], v[128:131], v[80:95]
    ds_read_b64_tr_b16 v[32:33], v17 offset:8192
    ds_read_b64_tr_b16 v[34:35], v17 offset:8704
    v_mfma_f32_32x32x16_bf16 v[80:95], v[36:39], v[132:135], v[80:95]
    ds_read_b64_tr_b16 v[36:37], v17 offset:10240
    ds_read_b64_tr_b16 v[38:39], v17 offset:10752
    v_mfma_f32_32x32x16_bf16 v[80:95], v[40:43], v[136:139], v[80:95]
    ds_read_b64_tr_b16 v[40:41], v17 offset:12288
    ds_read_b64_tr_b16 v[42:43], v17 offset:12800
    v_mfma_f32_32x32x16_bf16 v[80:95], v[44:47], v[140:143], v[80:95]
    ds_read_b64_tr_b16 v[44:45], v17 offset:14336
    ds_read_b64_tr_b16 v[46:47], v17 offset:14848
    v_mfma_f32_32x32x16_bf16 v[80:95], v[48:51], v[144:147], v[80:95]
    ds_read_b64_tr_b16 v[48:49], v17 offset:16384
    ds_read_b64_tr_b16 v[50:51], v17 offset:16896
    v_mfma_f32_32x32x16_bf16 v[80:95], v[52:55], v[148:151], v[80:95]
    ds_read_b64_tr_b16 v[52:53], v17 offset:18432
    ds_read_b64_tr_b16 v[54:55], v17 offset:18944
    v_mfma_f32_32x32x16_bf16 v[80:95], v[56:59], v[152:155], v[80:95]
    ds_read_b64_tr_b16 v[56:57], v17 offset:20480
    ds_read_b64_tr_b16 v[58:59], v17 offset:20992
    v_mfma_f32_32x32x16_bf16 v[80:95], v[60:63], v[156:159], v[80:95]
    ds_read_b64_tr_b16 v[60:61], v17 offset:22528
    ds_read_b64_tr_b16 v[62:63], v17 offset:23040
    s_waitcnt vmcnt(5)
    s_barrier
    s_waitcnt lgkmcnt(12)
    v_mfma_f32_32x32x16_bf16 v[80:95], v[32:35], v[160:163], v[80:95]
    ds_read_b64_tr_b16 v[32:33], v17 offset:24576
    ds_read_b64_tr_b16 v[34:35], v17 offset:25088
    v_mfma_f32_32x32x16_bf16 v[80:95], v[36:39], v[164:167], v[80:95]
    ds_read_b64_tr_b16 v[36:37], v17 offset:26624
    ds_read_b64_tr_b16 v[38:39], v17 offset:27136
    s_waitcnt lgkmcnt(12)
    v_mfma_f32_32x32x16_bf16 v[80:95], v[40:43], v[168:171], v[80:95]
    ds_read_b64_tr_b16 v[40:41], v17 offset:28672
    ds_read_b64_tr_b16 v[42:43], v17 offset:29184
    v_mfma_f32_32x32x16_bf16 v[80:95], v[44:47], v[172:175], v[80:95]
    ds_read_b64_tr_b16 v[44:45], v17 offset:30720
    ds_read_b64_tr_b16 v[46:47], v17 offset:31232
    s_waitcnt lgkmcnt(12)
    v_mfma_f32_32x32x16_bf16 v[80:95], v[48:51], v[176:179], v[80:95]
    ds_read_b64_tr_b16 v[48:49], v17 offset:32768
    ds_read_b64_tr_b16 v[50:51], v17 offset:33280
    v_mfma_f32_32x32x16_bf16 v[80:95], v[52:55], v[180:183], v[80:95]
    ds_read_b64_tr_b16 v[52:53], v17 offset:34816
    ds_read_b64_tr_b16 v[54:55], v17 offset:35328
    s_waitcnt lgkmcnt(12)
    v_mfma_f32_32x32x16_bf16 v[80:95], v[56:59], v[184:187], v[80:95]
    ds_read_b64_tr_b16 v[56:57], v17 offset:36864
    ds_read_b64_tr_b16 v[58:59], v17 offset:37376
    v_mfma_f32_32x32x16_bf16 v[80:95], v[60:63], v[188:191], v[80:95]
    ds_read_b64_tr_b16 v[60:61], v17 offset:38912
    ds_read_b64_tr_b16 v[62:63], v17 offset:39424
    s_waitcnt vmcnt(1)
    s_barrier
    s_waitcnt lgkmcnt(12)
    v_mfma_f32_32x32x16_bf16 v[80:95], v[32:35], v[192:195], v[80:95]
    ds_read_b64_tr_b16 v[32:33], v16 offset:0
    ds_read_b64_tr_b16 v[34:35], v16 offset:512
    v_mfma_f32_32x32x16_bf16 v[80:95], v[36:39], v[196:199], v[80:95]
    ds_read_b64_tr_b16 v[36:37], v16 offset:2048
    ds_read_b64_tr_b16 v[38:39], v16 offset:2560
    s_waitcnt lgkmcnt(12)
    v_mfma_f32_32x32x16_bf16 v[80:95], v[40:43], v[200:203], v[80:95]
    ds_read_b64_tr_b16 v[40:41], v16 offset:4096
    ds_read_b64_tr_b16 v[42:43], v16 offset:4608
    v_mfma_f32_32x32x16_bf16 v[80:95], v[44:47], v[204:207], v[80:95]
    ds_read_b64_tr_b16 v[44:45], v16 offset:6144
    ds_read_b64_tr_b16 v[46:47], v16 offset:6656
    s_waitcnt lgkmcnt(12)
    v_mfma_f32_32x32x16_bf16 v[80:95], v[48:51], v[208:211], v[80:95]
    ds_read_b64_tr_b16 v[48:49], v16 offset:8192
    ds_read_b64_tr_b16 v[50:51], v16 offset:8704
    v_mfma_f32_32x32x16_bf16 v[80:95], v[52:55], v[212:215], v[80:95]
    ds_read_b64_tr_b16 v[52:53], v16 offset:10240
    ds_read_b64_tr_b16 v[54:55], v16 offset:10752
    s_waitcnt lgkmcnt(12)
    v_mfma_f32_32x32x16_bf16 v[80:95], v[56:59], v[216:219], v[80:95]
    ds_read_b64_tr_b16 v[56:57], v16 offset:12288
    ds_read_b64_tr_b16 v[58:59], v16 offset:12800
    v_mfma_f32_32x32x16_bf16 v[80:95], v[60:63], v[220:223], v[80:95]
    ds_read_b64_tr_b16 v[60:61], v16 offset:14336
    ds_read_b64_tr_b16 v[62:63], v16 offset:14848
    s_barrier
    s_waitcnt lgkmcnt(12)
    v_mfma_f32_32x32x16_bf16 v[80:95], v[32:35], v[224:227], v[80:95]
    v_mfma_f32_32x32x16_bf16 v[80:95], v[36:39], v[228:231], v[80:95]
    s_waitcnt lgkmcnt(8)
    v_mfma_f32_32x32x16_bf16 v[80:95], v[40:43], v[232:235], v[80:95]
    v_mfma_f32_32x32x16_bf16 v[80:95], v[44:47], v[236:239], v[80:95]
    s_waitcnt lgkmcnt(4)
    v_mfma_f32_32x32x16_bf16 v[80:95], v[48:51], v[240:243], v[80:95]
    v_mfma_f32_32x32x16_bf16 v[80:95], v[52:55], v[244:247], v[80:95]
    s_waitcnt lgkmcnt(0)
    v_mfma_f32_32x32x16_bf16 v[80:95], v[56:59], v[248:251], v[80:95]
    v_mfma_f32_32x32x16_bf16 v[80:95], v[60:63], v[252:255], v[80:95]
    s_barrier
    s_cmp_eq_u32 s39, 0
    s_cbranch_scc1 L_b_w0a
    s_mov_b32 s61, 0
    s_add_u32 m0, s60, 16384
    s_nop 0
    buffer_load_dwordx4 v6, s[48:51], s61 offen  lds
    buffer_load_dwordx4 v7, s[48:51], s61 offen offset:1024  lds
    s_mov_b32 s61, 65536
    s_add_u32 m0, s60, 24576
    s_nop 0
    buffer_load_dwordx4 v6, s[48:51], s61 offen  lds
    buffer_load_dwordx4 v7, s[48:51], s61 offen offset:1024  lds
    s_mov_b32 s61, 131072
    s_add_u32 m0, s60, 32768
    s_nop 0
    buffer_load_dwordx4 v6, s[48:51], s61 offen  lds
    buffer_load_dwordx4 v7, s[48:51], s61 offen offset:1024  lds
    s_mov_b32 s61, 196608
    s_add_u32 m0, s60, 40960
    s_nop 0
    buffer_load_dwordx4 v6, s[48:51], s61 offen  lds
    buffer_load_dwordx4 v7, s[48:51], s61 offen offset:1024  lds
    s_mov_b32 s61, 262144
    s_add_u32 m0, s60, 49152
    s_nop 0
    buffer_load_dwordx4 v6, s[48:51], s61 offen  lds
    buffer_load_dwordx4 v7, s[48:51], s61 offen offset:1024  lds
    s_mov_b32 s61, 327680
    s_add_u32 m0, s60, 57344
    s_nop 0
    buffer_load_dwordx4 v6, s[48:51], s61 offen  lds
    buffer_load_dwordx4 v7, s[48:51], s61 offen offset:1024  lds
    s_mov_b32 s61, 393216
    s_add_u32 m0, s60, 65536
    s_nop 0
    buffer_load_dwordx4 v6, s[48:51], s61 offen  lds
    buffer_load_dwordx4 v7, s[48:51], s61 offen offset:1024  lds
    s_mov_b32 s61, 458752
    s_add_u32 m0, s60, 73728
    s_nop 0
    buffer_load_dwordx4 v6, s[48:51], s61 offen  lds
    buffer_load_dwordx4 v7, s[48:51], s61 offen offset:1024  lds
    s_cmp_eq_u32 s39, 1
    s_cbranch_scc0 L_b_noshare
    v_subrev_u32 v22, 16384, v6
    v_subrev_u32 v23, 16384, v7
    s_mov_b32 m0, 16384
    s_mov_b32 s61, 0
    buffer_load_dwordx4 v22, s[48:51], s61 offen lds
    buffer_load_dwordx4 v23, s[48:51], s61 offen offset:1024 lds
    s_mov_b32 m0, 24576
    s_mov_b32 s61, 65536
    buffer_load_dwordx4 v22, s[48:51], s61 offen lds
    buffer_load_dwordx4 v23, s[48:51], s61 offen offset:1024 lds
    s_mov_b32 m0, 32768
    s_mov_b32 s61, 131072
    buffer_load_dwordx4 v22, s[48:51], s61 offen lds
    buffer_load_dwordx4 v23, s[48:51], s61 offen offset:1024 lds
    s_mov_b32 m0, 40960
    s_mov_b32 s61, 196608
    buffer_load_dwordx4 v22, s[48:51], s61 offen lds
    buffer_load_dwordx4 v23, s[48:51], s61 offen offset:1024 lds
    s_mov_b32 m0, 49152
    s_mov_b32 s61, 262144
    buffer_load_dwordx4 v22, s[48:51], s61 offen lds
    buffer_load_dwordx4 v23, s[48:51], s61 offen offset:1024 lds
    s_mov_b32 m0, 57344
    s_mov_b32 s61, 327680
    buffer_load_dwordx4 v22, s[48:51], s61 offen lds
    buffer_load_dwordx4 v23, s[48:51], s61 offen offset:1024 lds
    s_mov_b32 m0, 65536
    s_mov_b32 s61, 393216
    buffer_load_dwordx4 v22, s[48:51], s61 offen lds
    buffer_load_dwordx4 v23, s[48:51], s61 offen offset:1024 lds
    s_mov_b32 m0, 73728
    s_mov_b32 s61, 458752
    buffer_load_dwordx4 v22, s[48:51], s61 offen lds
    buffer_load_dwordx4 v23, s[48:51], s61 offen offset:1024 lds
L_b_noshare:
    s_branch L_b_phi
L_b_w0a:
    s_lshr_b32 s66, s3, 4
    s_and_b32 s67, s3, 15
    s_mul_i32 s69, s66, 69632
    s_add_u32 s69, s69, 10551296
    s_lshl_b32 s52, s67, 7
    s_add_u32 s68, s69, s52
    v_and_b32 v22, 7, v1
    v_lshlrev_b32 v22, 4, v22
    v_lshrrev_b32 v23, 3, v1
    v_mul_u32_u24 v23, 2176, v23
    v_add_u32 v23, v22, v23
    v_add_u32 v24, s68, v23
    v_add_u32 v25, 17408, v24
    v_add_u32 v26, 34816, v24
    v_add_u32 v27, 52224, v24
    s_add_u32 s68, s69, 2048
    v_add_u32 v8, s68, v23
    v_add_u32 v9, 17408, v8
    v_add_u32 v10, 34816, v8
    v_add_u32 v11, 52224, v8
    s_mul_i32 s69, s66, 2176
    s_add_u32 s69, s69, 12582912
    s_add_u32 s68, s69, s52
    v_add_u32 v23, s68, v22
    s_add_u32 s68, s69, 2048
    v_add_u32 v29, s68, v22
    global_load_dwordx4 v[96:99], v24, s[36:37] sc1
    global_load_dwordx4 v[100:103], v25, s[36:37] sc1
    global_load_dwordx4 v[104:107], v26, s[36:37] sc1
    global_load_dwordx4 v[108:111], v27, s[36:37] sc1
    s_cmp_lg_u32 s67, 0
    s_cbranch_scc1 L_b_red_nb0
    global_load_dwordx4 v[112:115], v8, s[36:37] sc1
    global_load_dwordx4 v[116:119], v9, s[36:37] sc1
    global_load_dwordx4 v[120:123], v10, s[36:37] sc1
    global_load_dwordx4 v[124:127], v11, s[36:37] sc1
L_b_red_nb0:
L_b_phi:
    v_mul_f32 v64, s62, v80
    v_mul_f32 v65, s62, v81
    v_mul_f32 v66, s62, v82
    v_mul_f32 v67, s62, v83
    v_mul_f32 v68, s62, v84
    v_mul_f32 v69, s62, v85
    v_mul_f32 v70, s62, v86
    v_mul_f32 v71, s62, v87
    v_mul_f32 v72, s62, v88
    v_mul_f32 v73, s62, v89
    v_mul_f32 v74, s62, v90
    v_mul_f32 v75, s62, v91
    v_mul_f32 v76, s62, v92
    v_mul_f32 v77, s62, v93
    v_mul_f32 v78, s62, v94
    v_mul_f32 v79, s62, v95
    v_exp_f32 v64, v64 clamp
    v_max_f32 v80, s64, v80
    v_exp_f32 v65, v65 clamp
    v_max_f32 v81, s64, v81
    v_exp_f32 v66, v66 clamp
    v_max_f32 v82, s64, v82
    v_exp_f32 v67, v67 clamp
    v_max_f32 v83, s64, v83
    v_exp_f32 v68, v68 clamp
    v_max_f32 v84, s64, v84
    v_exp_f32 v69, v69 clamp
    v_max_f32 v85, s64, v85
    v_exp_f32 v70, v70 clamp
    v_max_f32 v86, s64, v86
    v_exp_f32 v71, v71 clamp
    v_max_f32 v87, s64, v87
    v_exp_f32 v72, v72 clamp
    v_max_f32 v88, s64, v88
    v_exp_f32 v73, v73 clamp
    v_max_f32 v89, s64, v89
    v_exp_f32 v74, v74 clamp
    v_max_f32 v90, s64, v90
    v_exp_f32 v75, v75 clamp
    v_max_f32 v91, s64, v91
    v_exp_f32 v76, v76 clamp
    v_max_f32 v92, s64, v92
    v_exp_f32 v77, v77 clamp
    v_max_f32 v93, s64, v93
    v_exp_f32 v78, v78 clamp
    v_max_f32 v94, s64, v94
    v_exp_f32 v79, v79 clamp
    v_max_f32 v95, s64, v95
    v_add_f32 v80, v80, v64
    v_add_f32 v81, v81, v65
    v_add_f32 v82, v82, v66
    v_add_f32 v83, v83, v67
    v_add_f32 v84, v84, v68
    v_add_f32 v85, v85, v69
    v_add_f32 v86, v86, v70
    v_add_f32 v87, v87, v71
    v_add_f32 v88, v88, v72
    v_add_f32 v89, v89, v73
    v_add_f32 v90, v90, v74
    v_add_f32 v91, v91, v75
    v_add_f32 v92, v92, v76
    v_add_f32 v93, v93, v77
    v_add_f32 v94, v94, v78
    v_add_f32 v95, v95, v79
    v_cvt_pk_bf16_f32 v80, v80, v81
    v_cvt_pk_bf16_f32 v81, v82, v83
    v_cvt_pk_bf16_f32 v82, v84, v85
    v_cvt_pk_bf16_f32 v83, v86, v87
    v_cvt_pk_bf16_f32 v84, v88, v89
    v_cvt_pk_bf16_f32 v85, v90, v91
    v_cvt_pk_bf16_f32 v86, v92, v93
    v_cvt_pk_bf16_f32 v87, v94, v95
    v_lshlrev_b32 v20, 4, v1
    s_cmp_lg_u32 s39, 0
    s_cbranch_scc1 L_b_noho
    ds_write_b128 v20, v[80:83]
    ds_write_b128 v20, v[84:87] offset:1024
    v_mov_b32 v21, 0
    ds_write_b32 v21, v21 offset:2048
    s_waitcnt lgkmcnt(0)
L_b_noho:
    s_barrier
    s_setprio 1
    s_cmp_eq_u32 s39, 0
    s_cbranch_scc1 L_b_w0b
    global_store_dwordx4 v28, v[80:83], s[36:37] sc1
    global_store_dwordx4 v28, v[84:87], s[36:37] offset:1024 sc1
    s_cmp_eq_u32 s39, 1
    s_cbranch_scc0 L_b_nopq
    ds_read_b128 v[32:35], v20
    ds_read_b128 v[36:39], v20 offset:1024
    v_subrev_u32 v21, 32768, v28
    s_waitcnt lgkmcnt(0)
    global_store_dwordx4 v21, v[32:35], s[36:37] sc1
    global_store_dwordx4 v21, v[36:39], s[36:37] offset:1024 sc1
L_b_nopq:
    s_mov_b32 s40, s36
    s_and_b32 s41, s37, 0xffff
    s_mov_b32 s42, 12648448
    s_mov_b32 s43, 0x20000
    s_lshl_b32 s68, s56, 1
    s_add_u32 s68, s68, s58
    s_lshl_b32 s68, s68, 5
    s_lshl_b32 s69, s59, 4
    s_add_u32 s68, s68, s69
    s_lshl_b32 s68, s68, 10
    s_add_u32 s68, s68, 8388608
    v_lshl_add_u32 v3, v1, 4, s68
    v_add_u32 v31, 8192, v3
    v_lshrrev_b32 v13, 7, v0
    v_mul_u32_u24 v13, 2176, v13
    v_and_b32 v20, 127, v0
    v_lshl_add_u32 v13, v20, 4, v13
    v_add_u32 v13, 12582912, v13
    v_lshrrev_b32 v14, 3, v20
    v_mul_u32_u24 v14, 2176, v14
    v_and_b32 v21, 7, v0
    v_lshl_add_u32 v14, v21, 4, v14
    v_add_u32 v14, 12584960, v14
    v_lshrrev_b32 v15, 7, v0
    v_lshlrev_b32 v15, 1, v15
    v_bfe_u32 v21, v0, 4, 1
    v_add_u32 v15, v15, v21
    v_mul_u32_u24 v15, 544, v15
    v_bfe_u32 v21, v0, 5, 1
    v_mul_u32_u24 v21, 272, v21
    v_add_u32 v15, v15, v21
    v_and_b32 v21, 15, v0
    v_lshl_add_u32 v15, v21, 4, v15
    v_bfe_u32 v21, v0, 6, 1
    v_lshl_add_u32 v15, v21, 3, v15
    v_lshrrev_b32 v12, 3, v20
    v_lshlrev_b32 v12, 1, v12
    v_bfe_u32 v21, v0, 2, 1
    v_add_u32 v12, v12, v21
    v_mul_u32_u24 v12, 544, v12
    v_bfe_u32 v21, v0, 1, 1
    v_mul_u32_u24 v21, 272, v21
    v_add_u32 v12, v12, v21
    v_and_b32 v21, 1, v0
    v_lshl_add_u32 v12, v21, 3, v12
    v_add_u32 v12, 256, v12
    v_and_b32 v30, 15, v1
    v_mul_u32_u24 v30, 2176, v30
    v_add_u32 v30, 12584960, v30
    s_mov_b32 s8, 0
    s_mov_b32 s9, 1024
    s_mov_b32 s10, 2048
    s_mov_b32 s11, 3072
    s_mov_b32 s12, 4096
    s_mov_b32 s13, 5120
    s_mov_b32 s14, 6144
    s_mov_b32 s15, 7168
    s_mov_b32 s16, 0
    s_mov_b32 s17, 4352
    s_mov_b32 s18, 8704
    s_mov_b32 s19, 13056
    s_mov_b32 s20, 17408
    s_mov_b32 s21, 21760
    s_mov_b32 s22, 26112
    s_mov_b32 s23, 30464
    s_waitcnt vmcnt(0)
    v_mov_b32 v32, 0
    v_mov_b32 v33, 1
    s_mov_b64 exec, 1
    ds_add_rtn_u32 v34, v32, v33 offset:2048
    s_waitcnt lgkmcnt(0)
    v_readfirstlane_b32 s68, v34
    s_nop 0
    s_cmp_lg_u32 s68, 2
    s_cbranch_scc1 L_b_noflag2
    s_lshl_b32 s68, s56, 7
    s_lshl_b32 s69, s57, 2
    s_add_u32 s68, s68, s69
    s_add_u32 s68, s68, 10485760
    v_mov_b32 v32, s68
    v_mov_b32 v33, s38
    global_store_dword v32, v33, s[36:37] sc1
L_b_noflag2:
    s_mov_b64 exec, -1
    s_branch L_b_tailjoin
L_b_w0b:
    s_mov_b32 s61, 0
    s_branch L_b_red_w
L_b_red_poll:
    global_load_dwordx4 v[96:99], v24, s[36:37] sc1
    global_load_dwordx4 v[100:103], v25, s[36:37] sc1
    global_load_dwordx4 v[104:107], v26, s[36:37] sc1
    global_load_dwordx4 v[108:111], v27, s[36:37] sc1
    s_cmp_lg_u32 s67, 0
    s_cbranch_scc1 L_b_red_nb1
    global_load_dwordx4 v[112:115], v8, s[36:37] sc1
    global_load_dwordx4 v[116:119], v9, s[36:37] sc1
    global_load_dwordx4 v[120:123], v10, s[36:37] sc1
    global_load_dwordx4 v[124:127], v11, s[36:37] sc1
L_b_red_nb1:
L_b_red_w:
    s_add_u32 s61, s61, 1
    s_waitcnt vmcnt(0)
    s_cmp_lg_u32 s67, 0
    s_cbranch_scc1 L_b_red_one
    v_xor_b32 v20, s38, v97
    v_bitop3_b32 v20, v20, v99, s38 bitop3:0xf6
    v_bitop3_b32 v20, v20, v101, s38 bitop3:0xf6
    v_bitop3_b32 v20, v20, v103, s38 bitop3:0xf6
    v_bitop3_b32 v20, v20, v105, s38 bitop3:0xf6
    v_bitop3_b32 v20, v20, v107, s38 bitop3:0xf6
    v_bitop3_b32 v20, v20, v109, s38 bitop3:0xf6
    v_bitop3_b32 v20, v20, v111, s38 bitop3:0xf6
    v_bitop3_b32 v20, v20, v113, s38 bitop3:0xf6
    v_bitop3_b32 v20, v20, v115, s38 bitop3:0xf6
    v_bitop3_b32 v20, v20, v117, s38 bitop3:0xf6
    v_bitop3_b32 v20, v20, v119, s38 bitop3:0xf6
    v_bitop3_b32 v20, v20, v121, s38 bitop3:0xf6
    v_bitop3_b32 v20, v20, v123, s38 bitop3:0xf6
    v_bitop3_b32 v20, v20, v125, s38 bitop3:0xf6
    v_bitop3_b32 v20, v20, v127, s38 bitop3:0xf6
    v_cmp_ne_u32 vcc, 0, v20
    s_branch L_b_red_chk
L_b_red_one:
    v_xor_b32 v20, s38, v97
    v_bitop3_b32 v20, v20, v99, s38 bitop3:0xf6
    v_bitop3_b32 v20, v20, v101, s38 bitop3:0xf6
    v_bitop3_b32 v20, v20, v103, s38 bitop3:0xf6
    v_bitop3_b32 v20, v20, v105, s38 bitop3:0xf6
    v_bitop3_b32 v20, v20, v107, s38 bitop3:0xf6
    v_bitop3_b32 v20, v20, v109, s38 bitop3:0xf6
    v_bitop3_b32 v20, v20, v111, s38 bitop3:0xf6
    v_cmp_ne_u32 vcc, 0, v20
L_b_red_chk:
    s_cmp_gt_u32 s61, 200000
    s_cbranch_scc1 L_b_red_go
    s_cbranch_vccz L_b_red_go
    s_sleep 1
    s_branch L_b_red_poll
L_b_red_go:
    s_cmp_lg_u32 s67, 0
    s_cbranch_scc1 L_b_red_a
    v_lshlrev_b32 v64, 16, v112
    v_and_b32 v65, 0xffff0000, v112
    v_lshlrev_b32 v66, 16, v114
    v_and_b32 v67, 0xffff0000, v114
    v_lshlrev_b32 v68, 16, v116
    v_and_b32 v69, 0xffff0000, v116
    v_add_f32 v64, v64, v68
    v_add_f32 v65, v65, v69
    v_lshlrev_b32 v70, 16, v118
    v_and_b32 v71, 0xffff0000, v118
    v_add_f32 v66, v66, v70
    v_add_f32 v67, v67, v71
    v_lshlrev_b32 v68, 16, v120
    v_and_b32 v69, 0xffff0000, v120
    v_add_f32 v64, v64, v68
    v_add_f32 v65, v65, v69
    v_lshlrev_b32 v70, 16, v122
    v_and_b32 v71, 0xffff0000, v122
    v_add_f32 v66, v66, v70
    v_add_f32 v67, v67, v71
    v_lshlrev_b32 v68, 16, v124
    v_and_b32 v69, 0xffff0000, v124
    v_add_f32 v64, v64, v68
    v_add_f32 v65, v65, v69
    v_lshlrev_b32 v70, 16, v126
    v_and_b32 v71, 0xffff0000, v126
    v_add_f32 v66, v66, v70
    v_add_f32 v67, v67, v71
    v_add_f32_dpp v64, v64, v64 row_ror:8 row_mask:0xf bank_mask:0xf
    v_add_f32_dpp v65, v65, v65 row_ror:8 row_mask:0xf bank_mask:0xf
    v_add_f32_dpp v66, v66, v66 row_ror:8 row_mask:0xf bank_mask:0xf
    v_add_f32_dpp v67, v67, v67 row_ror:8 row_mask:0xf bank_mask:0xf
    v_mov_b32 v68, v64
    v_mov_b32 v69, v65
    v_mov_b32 v70, v66
    v_mov_b32 v71, v67
    v_permlane16_swap_b32 v64, v68
    v_permlane16_swap_b32 v65, v69
    v_permlane16_swap_b32 v66, v70
    v_permlane16_swap_b32 v67, v71
    v_add_f32 v64, v64, v68
    v_add_f32 v65, v65, v69
    v_add_f32 v66, v66, v70
    v_add_f32 v67, v67, v71
    v_mov_b32 v68, v64
    v_mov_b32 v69, v65
    v_mov_b32 v70, v66
    v_mov_b32 v71, v67
    v_permlane32_swap_b32 v64, v68
    v_permlane32_swap_b32 v65, v69
    v_permlane32_swap_b32 v66, v70
    v_permlane32_swap_b32 v67, v71
    v_add_f32 v64, v64, v68
    v_add_f32 v65, v65, v69
    v_add_f32 v66, v66, v70
    v_add_f32 v67, v67, v71
    v_cvt_pk_bf16_f32 v72, v64, v65
    v_mov_b32 v73, s38
    v_cvt_pk_bf16_f32 v74, v66, v67
    v_mov_b32 v75, s38
    s_mov_b64 exec, 0xff
    global_store_dwordx4 v29, v[72:75], s[36:37] sc1
    s_mov_b64 exec, -1
L_b_red_a:
    v_lshlrev_b32 v64, 16, v96
    v_and_b32 v65, 0xffff0000, v96
    v_lshlrev_b32 v66, 16, v98
    v_and_b32 v67, 0xffff0000, v98
    v_lshlrev_b32 v68, 16, v100
    v_and_b32 v69, 0xffff0000, v100
    v_add_f32 v64, v64, v68
    v_add_f32 v65, v65, v69
    v_lshlrev_b32 v70, 16, v102
    v_and_b32 v71, 0xffff0000, v102
    v_add_f32 v66, v66, v70
    v_add_f32 v67, v67, v71
    v_lshlrev_b32 v68, 16, v104
    v_and_b32 v69, 0xffff0000, v104
    v_add_f32 v64, v64, v68
    v_add_f32 v65, v65, v69
    v_lshlrev_b32 v70, 16, v106
    v_and_b32 v71, 0xffff0000, v106
    v_add_f32 v66, v66, v70
    v_add_f32 v67, v67, v71
    v_lshlrev_b32 v68, 16, v108
    v_and_b32 v69, 0xffff0000, v108
    v_add_f32 v64, v64, v68
    v_add_f32 v65, v65, v69
    v_lshlrev_b32 v70, 16, v110
    v_and_b32 v71, 0xffff0000, v110
    v_add_f32 v66, v66, v70
    v_add_f32 v67, v67, v71
    v_add_f32_dpp v64, v64, v64 row_ror:8 row_mask:0xf bank_mask:0xf
    v_add_f32_dpp v65, v65, v65 row_ror:8 row_mask:0xf bank_mask:0xf
    v_add_f32_dpp v66, v66, v66 row_ror:8 row_mask:0xf bank_mask:0xf
    v_add_f32_dpp v67, v67, v67 row_ror:8 row_mask:0xf bank_mask:0xf
    v_mov_b32 v68, v64
    v_mov_b32 v69, v65
    v_mov_b32 v70, v66
    v_mov_b32 v71, v67
    v_permlane16_swap_b32 v64, v68
    v_permlane16_swap_b32 v65, v69
    v_permlane16_swap_b32 v66, v70
    v_permlane16_swap_b32 v67, v71
    v_add_f32 v64, v64, v68
    v_add_f32 v65, v65, v69
    v_add_f32 v66, v66, v70
    v_add_f32 v67, v67, v71
    v_mov_b32 v68, v64
    v_mov_b32 v69, v65
    v_mov_b32 v70, v66
    v_mov_b32 v71, v67
    v_permlane32_swap_b32 v64, v68
    v_permlane32_swap_b32 v65, v69
    v_permlane32_swap_b32 v66, v70
    v_permlane32_swap_b32 v67, v71
    v_add_f32 v64, v64, v68
    v_add_f32 v65, v65, v69
    v_add_f32 v66, v66, v70
    v_add_f32 v67, v67, v71
    v_cvt_pk_bf16_f32 v72, v64, v65
    v_mov_b32 v73, s38
    v_cvt_pk_bf16_f32 v74, v66, v67
    v_mov_b32 v75, s38
    s_mov_b64 exec, 0xff
    global_store_dwordx4 v23, v[72:75], s[36:37] sc1
    s_mov_b64 exec, -1
    s_mov_b32 s40, s36
    s_and_b32 s41, s37, 0xffff
    s_mov_b32 s42, 12648448
    s_mov_b32 s43, 0x20000
    s_lshl_b32 s68, s56, 1
    s_add_u32 s68, s68, s58
    s_lshl_b32 s68, s68, 5
    s_lshl_b32 s69, s59, 4
    s_add_u32 s68, s68, s69
    s_lshl_b32 s68, s68, 10
    s_add_u32 s68, s68, 8388608
    v_lshl_add_u32 v3, v1, 4, s68
    v_add_u32 v31, 8192, v3
    v_lshrrev_b32 v13, 7, v0
    v_mul_u32_u24 v13, 2176, v13
    v_and_b32 v20, 127, v0
    v_lshl_add_u32 v13, v20, 4, v13
    v_add_u32 v13, 12582912, v13
    v_lshrrev_b32 v14, 3, v20
    v_mul_u32_u24 v14, 2176, v14
    v_and_b32 v21, 7, v0
    v_lshl_add_u32 v14, v21, 4, v14
    v_add_u32 v14, 12584960, v14
    v_lshrrev_b32 v15, 7, v0
    v_lshlrev_b32 v15, 1, v15
    v_bfe_u32 v21, v0, 4, 1
    v_add_u32 v15, v15, v21
    v_mul_u32_u24 v15, 544, v15
    v_bfe_u32 v21, v0, 5, 1
    v_mul_u32_u24 v21, 272, v21
    v_add_u32 v15, v15, v21
    v_and_b32 v21, 15, v0
    v_lshl_add_u32 v15, v21, 4, v15
    v_bfe_u32 v21, v0, 6, 1
    v_lshl_add_u32 v15, v21, 3, v15
    v_lshrrev_b32 v12, 3, v20
    v_lshlrev_b32 v12, 1, v12
    v_bfe_u32 v21, v0, 2, 1
    v_add_u32 v12, v12, v21
    v_mul_u32_u24 v12, 544, v12
    v_bfe_u32 v21, v0, 1, 1
    v_mul_u32_u24 v21, 272, v21
    v_add_u32 v12, v12, v21
    v_and_b32 v21, 1, v0
    v_lshl_add_u32 v12, v21, 3, v12
    v_add_u32 v12, 256, v12
    v_and_b32 v30, 15, v1
    v_mul_u32_u24 v30, 2176, v30
    v_add_u32 v30, 12584960, v30
    s_mov_b32 s8, 0
    s_mov_b32 s9, 1024
    s_mov_b32 s10, 2048
    s_mov_b32 s11, 3072
    s_mov_b32 s12, 4096
    s_mov_b32 s13, 5120
    s_mov_b32 s14, 6144
    s_mov_b32 s15, 7168
    s_mov_b32 s16, 0
    s_mov_b32 s17, 4352
    s_mov_b32 s18, 8704
    s_mov_b32 s19, 13056
    s_mov_b32 s20, 17408
    s_mov_b32 s21, 21760
    s_mov_b32 s22, 26112
    s_mov_b32 s23, 30464
L_b_tailjoin:
    s_barrier
    ds_read_b64_tr_b16 v[128:129], v18 offset:0
    ds_read_b64_tr_b16 v[130:131], v18 offset:1024
    ds_read_b64_tr_b16 v[132:133], v19 offset:0
    ds_read_b64_tr_b16 v[134:135], v19 offset:1024
    ds_read_b64_tr_b16 v[136:137], v18 offset:2048
    ds_read_b64_tr_b16 v[138:139], v18 offset:3072
    ds_read_b64_tr_b16 v[140:141], v19 offset:2048
    ds_read_b64_tr_b16 v[142:143], v19 offset:3072
    ds_read_b64_tr_b16 v[144:145], v18 offset:4096
    ds_read_b64_tr_b16 v[146:147], v18 offset:5120
    ds_read_b64_tr_b16 v[148:149], v19 offset:4096
    ds_read_b64_tr_b16 v[150:151], v19 offset:5120
    ds_read_b64_tr_b16 v[152:153], v18 offset:6144
    ds_read_b64_tr_b16 v[154:155], v18 offset:7168
    ds_read_b64_tr_b16 v[156:157], v19 offset:6144
    ds_read_b64_tr_b16 v[158:159], v19 offset:7168
    ds_read_b64_tr_b16 v[160:161], v18 offset:8192
    ds_read_b64_tr_b16 v[162:163], v18 offset:9216
    ds_read_b64_tr_b16 v[164:165], v19 offset:8192
    ds_read_b64_tr_b16 v[166:167], v19 offset:9216
    ds_read_b64_tr_b16 v[168:169], v18 offset:10240
    ds_read_b64_tr_b16 v[170:171], v18 offset:11264
    ds_read_b64_tr_b16 v[172:173], v19 offset:10240
    ds_read_b64_tr_b16 v[174:175], v19 offset:11264
    ds_read_b64_tr_b16 v[176:177], v18 offset:12288
    ds_read_b64_tr_b16 v[178:179], v18 offset:13312
    ds_read_b64_tr_b16 v[180:181], v19 offset:12288
    ds_read_b64_tr_b16 v[182:183], v19 offset:13312
    ds_read_b64_tr_b16 v[184:185], v18 offset:14336
    ds_read_b64_tr_b16 v[186:187], v18 offset:15360
    ds_read_b64_tr_b16 v[188:189], v19 offset:14336
    ds_read_b64_tr_b16 v[190:191], v19 offset:15360
    ds_read_b64_tr_b16 v[192:193], v18 offset:16384
    ds_read_b64_tr_b16 v[194:195], v18 offset:17408
    ds_read_b64_tr_b16 v[196:197], v19 offset:16384
    ds_read_b64_tr_b16 v[198:199], v19 offset:17408
    ds_read_b64_tr_b16 v[200:201], v18 offset:18432
    ds_read_b64_tr_b16 v[202:203], v18 offset:19456
    ds_read_b64_tr_b16 v[204:205], v19 offset:18432
    ds_read_b64_tr_b16 v[206:207], v19 offset:19456
    ds_read_b64_tr_b16 v[208:209], v18 offset:20480
    ds_read_b64_tr_b16 v[210:211], v18 offset:21504
    ds_read_b64_tr_b16 v[212:213], v19 offset:20480
    ds_read_b64_tr_b16 v[214:215], v19 offset:21504
    ds_read_b64_tr_b16 v[216:217], v18 offset:22528
    ds_read_b64_tr_b16 v[218:219], v18 offset:23552
    ds_read_b64_tr_b16 v[220:221], v19 offset:22528
    ds_read_b64_tr_b16 v[222:223], v19 offset:23552
    ds_read_b64_tr_b16 v[224:225], v18 offset:24576
    ds_read_b64_tr_b16 v[226:227], v18 offset:25600
    ds_read_b64_tr_b16 v[228:229], v19 offset:24576
    ds_read_b64_tr_b16 v[230:231], v19 offset:25600
    ds_read_b64_tr_b16 v[232:233], v18 offset:26624
    ds_read_b64_tr_b16 v[234:235], v18 offset:27648
    ds_read_b64_tr_b16 v[236:237], v19 offset:26624
    ds_read_b64_tr_b16 v[238:239], v19 offset:27648
    ds_read_b64_tr_b16 v[240:241], v18 offset:28672
    ds_read_b64_tr_b16 v[242:243], v18 offset:29696
    ds_read_b64_tr_b16 v[244:245], v19 offset:28672
    ds_read_b64_tr_b16 v[246:247], v19 offset:29696
    ds_read_b64_tr_b16 v[248:249], v18 offset:30720
    ds_read_b64_tr_b16 v[250:251], v18 offset:31744
    ds_read_b64_tr_b16 v[252:253], v19 offset:30720
    ds_read_b64_tr_b16 v[254:255], v19 offset:31744
    s_waitcnt lgkmcnt(0)
    s_barrier
    s_mov_b32 s61, 0
L_b_pqf_poll:
    global_load_dword v21, v2, s[36:37] sc1
    s_add_u32 s61, s61, 1
    s_waitcnt vmcnt(0)
    v_cmp_ne_u32 vcc, s38, v21
    s_cmp_gt_u32 s61, 200000
    s_cbranch_scc1 L_b_pqf_go
    s_cbranch_vccz L_b_pqf_go
    s_branch L_b_pqf_poll
L_b_pqf_go:
    buffer_load_dwordx4 v[32:35], v3, s[40:43], s8 offen sc1
    buffer_load_dwordx4 v[36:39], v3, s[40:43], s9 offen sc1
    buffer_load_dwordx4 v[40:43], v3, s[40:43], s10 offen sc1
    buffer_load_dwordx4 v[44:47], v3, s[40:43], s11 offen sc1
    buffer_load_dwordx4 v[48:51], v3, s[40:43], s12 offen sc1
    buffer_load_dwordx4 v[52:55], v3, s[40:43], s13 offen sc1
    buffer_load_dwordx4 v[56:59], v3, s[40:43], s14 offen sc1
    buffer_load_dwordx4 v[60:63], v3, s[40:43], s15 offen sc1
    v_and_b32 v24, 31, v1
    s_lshl_b32 s68, s58, 5
    v_add_u32 v24, s68, v24
    v_mul_u32_u24 v24, 272, v24
    v_lshrrev_b32 v25, 5, v1
    v_lshl_add_u32 v24, v25, 4, v24
    s_mul_i32 s68, s59, 17408
    s_add_u32 s68, s68, 17408
    v_add_u32 v24, s68, v24
    v_lshrrev_b32 v26, 3, v0
    v_mul_u32_u24 v25, 272, v26
    v_and_b32 v27, 7, v0
    v_lshl_add_u32 v25, v27, 5, v25
    v_add_u32 v25, 17408, v25
    s_lshl_b32 s68, s56, 6
    v_add_u32 v26, s68, v26
    v_lshlrev_b32 v26, 11, v26
    s_lshl_b32 s68, s57, 7
    s_add_u32 s68, s68, 1024
    v_lshl_add_u32 v26, v27, 4, v26
    v_add_u32 v26, s68, v26
    v_add_u32 v27, 65536, v26
    v_and_b32 v22, 31, v1
    v_min_u32 v22, 16, v22
    v_lshlrev_b32 v22, 4, v22
    v_lshrrev_b32 v23, 5, v1
    v_mul_u32_u24 v23, 272, v23
    s_mul_i32 s68, s59, 8704
    v_add3_u32 v22, v22, v23, s68
    s_mov_b32 s61, 0
    s_branch L_b_kvf_first
L_b_kvf_poll:
    s_sleep 1
L_b_kvf_first:
    buffer_load_dwordx4 v[64:67], v13, s[40:43], s16 offen sc1
    buffer_load_dwordx4 v[68:71], v13, s[40:43], s17 offen sc1
    buffer_load_dwordx4 v[72:75], v13, s[40:43], s18 offen sc1
    buffer_load_dwordx4 v[76:79], v13, s[40:43], s19 offen sc1
    buffer_load_dwordx4 v[80:83], v13, s[40:43], s20 offen sc1
    buffer_load_dwordx4 v[84:87], v13, s[40:43], s21 offen sc1
    buffer_load_dwordx4 v[88:91], v13, s[40:43], s22 offen sc1
    buffer_load_dwordx4 v[92:95], v13, s[40:43], s23 offen sc1
    buffer_load_dwordx4 v[96:99], v14, s[40:43], 0 offen sc1
    s_waitcnt vmcnt(0)
L_b_ka_chk:
    s_add_u32 s61, s61, 1
    v_xor_b32 v20, s38, v65
    v_bitop3_b32 v20, v20, v67, s38 bitop3:0xf6
    v_bitop3_b32 v20, v20, v69, s38 bitop3:0xf6
    v_bitop3_b32 v20, v20, v71, s38 bitop3:0xf6
    v_bitop3_b32 v20, v20, v73, s38 bitop3:0xf6
    v_bitop3_b32 v20, v20, v75, s38 bitop3:0xf6
    v_bitop3_b32 v20, v20, v77, s38 bitop3:0xf6
    v_bitop3_b32 v20, v20, v79, s38 bitop3:0xf6
    v_bitop3_b32 v20, v20, v81, s38 bitop3:0xf6
    v_bitop3_b32 v20, v20, v83, s38 bitop3:0xf6
    v_bitop3_b32 v20, v20, v85, s38 bitop3:0xf6
    v_bitop3_b32 v20, v20, v87, s38 bitop3:0xf6
    v_bitop3_b32 v20, v20, v89, s38 bitop3:0xf6
    v_bitop3_b32 v20, v20, v91, s38 bitop3:0xf6
    v_bitop3_b32 v20, v20, v93, s38 bitop3:0xf6
    v_bitop3_b32 v20, v20, v95, s38 bitop3:0xf6
    v_bitop3_b32 v20, v20, v97, s38 bitop3:0xf6
    v_bitop3_b32 v20, v20, v99, s38 bitop3:0xf6
    v_cmp_ne_u32 vcc, 0, v20
    s_cmp_gt_u32 s61, 200000
    s_cbranch_scc1 L_b_kvf_go
    s_cbranch_vccnz L_b_kvf_poll
L_b_kvf_go:
    v_mov_b32 v65, v66
    ds_write_b64 v15, v[64:65] offset:0
    v_mov_b32 v69, v70
    ds_write_b64 v15, v[68:69] offset:2176
    v_mov_b32 v73, v74
    ds_write_b64 v15, v[72:73] offset:4352
    v_mov_b32 v77, v78
    ds_write_b64 v15, v[76:77] offset:6528
    v_mov_b32 v81, v82
    ds_write_b64 v15, v[80:81] offset:8704
    v_mov_b32 v85, v86
    ds_write_b64 v15, v[84:85] offset:10880
    v_mov_b32 v89, v90
    ds_write_b64 v15, v[88:89] offset:13056
    v_mov_b32 v93, v94
    ds_write_b64 v15, v[92:93] offset:15232
    v_mov_b32 v97, v98
    ds_write_b64 v12, v[96:97] offset:0
    s_waitcnt vmcnt(0) lgkmcnt(0)
    s_barrier
    s_setprio 3
    ds_read_b128 v[8:11], v22 offset:0
    ds_read_b128 v[12:15], v22 offset:544
    s_waitcnt lgkmcnt(1)
    v_mfma_f32_32x32x16_bf16 v[64:79], v[8:11], v[32:35], 0
    buffer_load_dwordx4 v[32:35], v31, s[40:43], s8 offen sc1
    s_waitcnt lgkmcnt(0)
    v_mfma_f32_32x32x16_bf16 v[80:95], v[12:15], v[36:39], 0
    buffer_load_dwordx4 v[36:39], v31, s[40:43], s9 offen sc1
    s_nop 7
    v_add_f32 v20, s64, v72
    v_rcp_f32 v20, v20
    ds_read_b128 v[8:11], v22 offset:1088
    v_mul_f32 v64, v64, v20
    v_mul_f32 v65, v65, v20
    v_mul_f32 v66, v66, v20
    v_mul_f32 v67, v67, v20
    v_mul_f32 v68, v68, v20
    v_mul_f32 v69, v69, v20
    v_mul_f32 v70, v70, v20
    v_mul_f32 v71, v71, v20
    v_cvt_pk_bf16_f32 v4, v64, v65
    v_cvt_pk_bf16_f32 v5, v66, v67
    v_cvt_pk_bf16_f32 v6, v68, v69
    v_cvt_pk_bf16_f32 v7, v70, v71
    s_waitcnt lgkmcnt(0)
    v_mfma_f32_32x32x16_bf16 v[64:79], v[8:11], v[40:43], 0
    buffer_load_dwordx4 v[40:43], v31, s[40:43], s10 offen sc1
    v_add_f32 v20, s64, v88
    v_rcp_f32 v20, v20
    ds_read_b128 v[12:15], v22 offset:1632
    v_mul_f32 v80, v80, v20
    v_mul_f32 v81, v81, v20
    v_mfma_f32_32x32x16_bf16 v[96:111], v[128:131], v[4:7], 0
    v_mul_f32 v82, v82, v20
    v_mul_f32 v83, v83, v20
    v_mul_f32 v84, v84, v20
    v_mul_f32 v85, v85, v20
    v_mul_f32 v86, v86, v20
    v_mfma_f32_32x32x16_bf16 v[112:127], v[132:135], v[4:7], 0
    v_mul_f32 v87, v87, v20
    v_cvt_pk_bf16_f32 v16, v80, v81
    v_cvt_pk_bf16_f32 v17, v82, v83
    v_cvt_pk_bf16_f32 v18, v84, v85
    v_cvt_pk_bf16_f32 v19, v86, v87
    s_waitcnt lgkmcnt(0)
    v_mfma_f32_32x32x16_bf16 v[80:95], v[12:15], v[44:47], 0
    buffer_load_dwordx4 v[44:47], v31, s[40:43], s11 offen sc1
    v_add_f32 v20, s64, v72
    v_rcp_f32 v20, v20
    ds_read_b128 v[8:11], v22 offset:2176
    v_mul_f32 v64, v64, v20
    v_mul_f32 v65, v65, v20
    v_mfma_f32_32x32x16_bf16 v[96:111], v[136:139], v[16:19], v[96:111]
    v_mul_f32 v66, v66, v20
    v_mul_f32 v67, v67, v20
    v_mul_f32 v68, v68, v20
    v_mul_f32 v69, v69, v20
    v_mul_f32 v70, v70, v20
    v_mfma_f32_32x32x16_bf16 v[112:127], v[140:143], v[16:19], v[112:127]
    v_mul_f32 v71, v71, v20
    v_cvt_pk_bf16_f32 v4, v64, v65
    v_cvt_pk_bf16_f32 v5, v66, v67
    v_cvt_pk_bf16_f32 v6, v68, v69
    v_cvt_pk_bf16_f32 v7, v70, v71
    s_waitcnt lgkmcnt(0)
    v_mfma_f32_32x32x16_bf16 v[64:79], v[8:11], v[48:51], 0
    buffer_load_dwordx4 v[48:51], v31, s[40:43], s12 offen sc1
    v_add_f32 v20, s64, v88
    v_rcp_f32 v20, v20
    ds_read_b128 v[12:15], v22 offset:2720
    v_mul_f32 v80, v80, v20
    v_mul_f32 v81, v81, v20
    v_mfma_f32_32x32x16_bf16 v[96:111], v[144:147], v[4:7], v[96:111]
    v_mul_f32 v82, v82, v20
    v_mul_f32 v83, v83, v20
    v_mul_f32 v84, v84, v20
    v_mul_f32 v85, v85, v20
    v_mul_f32 v86, v86, v20
    v_mfma_f32_32x32x16_bf16 v[112:127], v[148:151], v[4:7], v[112:127]
    v_mul_f32 v87, v87, v20
    v_cvt_pk_bf16_f32 v16, v80, v81
    v_cvt_pk_bf16_f32 v17, v82, v83
    v_cvt_pk_bf16_f32 v18, v84, v85
    v_cvt_pk_bf16_f32 v19, v86, v87
    s_waitcnt lgkmcnt(0)
    v_mfma_f32_32x32x16_bf16 v[80:95], v[12:15], v[52:55], 0
    buffer_load_dwordx4 v[52:55], v31, s[40:43], s13 offen sc1
    v_add_f32 v20, s64, v72
    v_rcp_f32 v20, v20
    ds_read_b128 v[8:11], v22 offset:3264
    v_mul_f32 v64, v64, v20
    v_mul_f32 v65, v65, v20
    v_mfma_f32_32x32x16_bf16 v[96:111], v[152:155], v[16:19], v[96:111]
    v_mul_f32 v66, v66, v20
    v_mul_f32 v67, v67, v20
    v_mul_f32 v68, v68, v20
    v_mul_f32 v69, v69, v20
    v_mul_f32 v70, v70, v20
    v_mfma_f32_32x32x16_bf16 v[112:127], v[156:159], v[16:19], v[112:127]
    v_mul_f32 v71, v71, v20
    v_cvt_pk_bf16_f32 v4, v64, v65
    v_cvt_pk_bf16_f32 v5, v66, v67
    v_cvt_pk_bf16_f32 v6, v68, v69
    v_cvt_pk_bf16_f32 v7, v70, v71
    s_waitcnt lgkmcnt(0)
    v_mfma_f32_32x32x16_bf16 v[64:79], v[8:11], v[56:59], 0
    buffer_load_dwordx4 v[56:59], v31, s[40:43], s14 offen sc1
    v_add_f32 v20, s64, v88
    v_rcp_f32 v20, v20
    ds_read_b128 v[12:15], v22 offset:3808
    v_mul_f32 v80, v80, v20
    v_mul_f32 v81, v81, v20
    v_mfma_f32_32x32x16_bf16 v[96:111], v[160:163], v[4:7], v[96:111]
    v_mul_f32 v82, v82, v20
    v_mul_f32 v83, v83, v20
    v_mul_f32 v84, v84, v20
    v_mul_f32 v85, v85, v20
    v_mul_f32 v86, v86, v20
    v_mfma_f32_32x32x16_bf16 v[112:127], v[164:167], v[4:7], v[112:127]
    v_mul_f32 v87, v87, v20
    v_cvt_pk_bf16_f32 v16, v80, v81
    v_cvt_pk_bf16_f32 v17, v82, v83
    v_cvt_pk_bf16_f32 v18, v84, v85
    v_cvt_pk_bf16_f32 v19, v86, v87
    s_waitcnt lgkmcnt(0)
    v_mfma_f32_32x32x16_bf16 v[80:95], v[12:15], v[60:63], 0
    buffer_load_dwordx4 v[60:63], v31, s[40:43], s15 offen sc1
    v_add_f32 v20, s64, v72
    v_rcp_f32 v20, v20
    ds_read_b128 v[8:11], v22 offset:4352
    v_mul_f32 v64, v64, v20
    v_mul_f32 v65, v65, v20
    v_mfma_f32_32x32x16_bf16 v[96:111], v[168:171], v[16:19], v[96:111]
    v_mul_f32 v66, v66, v20
    v_mul_f32 v67, v67, v20
    v_mul_f32 v68, v68, v20
    v_mul_f32 v69, v69, v20
    v_mul_f32 v70, v70, v20
    v_mfma_f32_32x32x16_bf16 v[112:127], v[172:175], v[16:19], v[112:127]
    v_mul_f32 v71, v71, v20
    v_cvt_pk_bf16_f32 v4, v64, v65
    v_cvt_pk_bf16_f32 v5, v66, v67
    v_cvt_pk_bf16_f32 v6, v68, v69
    v_cvt_pk_bf16_f32 v7, v70, v71
    s_waitcnt lgkmcnt(0)
    s_waitcnt vmcnt(7)
    v_mfma_f32_32x32x16_bf16 v[64:79], v[8:11], v[32:35], 0
    v_add_f32 v20, s64, v88
    v_rcp_f32 v20, v20
    ds_read_b128 v[12:15], v22 offset:4896
    v_mul_f32 v80, v80, v20
    v_mul_f32 v81, v81, v20
    v_mfma_f32_32x32x16_bf16 v[96:111], v[176:179], v[4:7], v[96:111]
    v_mul_f32 v82, v82, v20
    v_mul_f32 v83, v83, v20
    v_mul_f32 v84, v84, v20
    v_mul_f32 v85, v85, v20
    v_mul_f32 v86, v86, v20
    v_mfma_f32_32x32x16_bf16 v[112:127], v[180:183], v[4:7], v[112:127]
    v_mul_f32 v87, v87, v20
    v_cvt_pk_bf16_f32 v16, v80, v81
    v_cvt_pk_bf16_f32 v17, v82, v83
    v_cvt_pk_bf16_f32 v18, v84, v85
    v_cvt_pk_bf16_f32 v19, v86, v87
    s_waitcnt lgkmcnt(0)
    s_waitcnt vmcnt(6)
    v_mfma_f32_32x32x16_bf16 v[80:95], v[12:15], v[36:39], 0
    v_add_f32 v20, s64, v72
    v_rcp_f32 v20, v20
    ds_read_b128 v[8:11], v22 offset:5440
    v_mul_f32 v64, v64, v20
    v_mul_f32 v65, v65, v20
    v_mfma_f32_32x32x16_bf16 v[96:111], v[184:187], v[16:19], v[96:111]
    v_mul_f32 v66, v66, v20
    v_mul_f32 v67, v67, v20
    v_mul_f32 v68, v68, v20
    v_mul_f32 v69, v69, v20
    v_mul_f32 v70, v70, v20
    v_mfma_f32_32x32x16_bf16 v[112:127], v[188:191], v[16:19], v[112:127]
    v_mul_f32 v71, v71, v20
    v_cvt_pk_bf16_f32 v4, v64, v65
    v_cvt_pk_bf16_f32 v5, v66, v67
    v_cvt_pk_bf16_f32 v6, v68, v69
    v_cvt_pk_bf16_f32 v7, v70, v71
    s_waitcnt lgkmcnt(0)
    s_waitcnt vmcnt(5)
    v_mfma_f32_32x32x16_bf16 v[64:79], v[8:11], v[40:43], 0
    v_add_f32 v20, s64, v88
    v_rcp_f32 v20, v20
    ds_read_b128 v[12:15], v22 offset:5984
    v_mul_f32 v80, v80, v20
    v_mul_f32 v81, v81, v20
    v_mfma_f32_32x32x16_bf16 v[96:111], v[192:195], v[4:7], v[96:111]
    v_mul_f32 v82, v82, v20
    v_mul_f32 v83, v83, v20
    v_mul_f32 v84, v84, v20
    v_mul_f32 v85, v85, v20
    v_mul_f32 v86, v86, v20
    v_mfma_f32_32x32x16_bf16 v[112:127], v[196:199], v[4:7], v[112:127]
    v_mul_f32 v87, v87, v20
    v_cvt_pk_bf16_f32 v16, v80, v81
    v_cvt_pk_bf16_f32 v17, v82, v83
    v_cvt_pk_bf16_f32 v18, v84, v85
    v_cvt_pk_bf16_f32 v19, v86, v87
    s_waitcnt lgkmcnt(0)
    s_waitcnt vmcnt(4)
    v_mfma_f32_32x32x16_bf16 v[80:95], v[12:15], v[44:47], 0
    v_add_f32 v20, s64, v72
    v_rcp_f32 v20, v20
    ds_read_b128 v[8:11], v22 offset:6528
    v_mul_f32 v64, v64, v20
    v_mul_f32 v65, v65, v20
    v_mfma_f32_32x32x16_bf16 v[96:111], v[200:203], v[16:19], v[96:111]
    v_mul_f32 v66, v66, v20
    v_mul_f32 v67, v67, v20
    v_mul_f32 v68, v68, v20
    v_mul_f32 v69, v69, v20
    v_mul_f32 v70, v70, v20
    v_mfma_f32_32x32x16_bf16 v[112:127], v[204:207], v[16:19], v[112:127]
    v_mul_f32 v71, v71, v20
    v_cvt_pk_bf16_f32 v4, v64, v65
    v_cvt_pk_bf16_f32 v5, v66, v67
    v_cvt_pk_bf16_f32 v6, v68, v69
    v_cvt_pk_bf16_f32 v7, v70, v71
    s_waitcnt lgkmcnt(0)
    s_waitcnt vmcnt(3)
    v_mfma_f32_32x32x16_bf16 v[64:79], v[8:11], v[48:51], 0
    v_add_f32 v20, s64, v88
    v_rcp_f32 v20, v20
    ds_read_b128 v[12:15], v22 offset:7072
    v_mul_f32 v80, v80, v20
    v_mul_f32 v81, v81, v20
    v_mfma_f32_32x32x16_bf16 v[96:111], v[208:211], v[4:7], v[96:111]
    v_mul_f32 v82, v82, v20
    v_mul_f32 v83, v83, v20
    v_mul_f32 v84, v84, v20
    v_mul_f32 v85, v85, v20
    v_mul_f32 v86, v86, v20
    v_mfma_f32_32x32x16_bf16 v[112:127], v[212:215], v[4:7], v[112:127]
    v_mul_f32 v87, v87, v20
    v_cvt_pk_bf16_f32 v16, v80, v81
    v_cvt_pk_bf16_f32 v17, v82, v83
    v_cvt_pk_bf16_f32 v18, v84, v85
    v_cvt_pk_bf16_f32 v19, v86, v87
    s_waitcnt lgkmcnt(0)
    s_waitcnt vmcnt(2)
    v_mfma_f32_32x32x16_bf16 v[80:95], v[12:15], v[52:55], 0
    v_add_f32 v20, s64, v72
    v_rcp_f32 v20, v20
    ds_read_b128 v[8:11], v22 offset:7616
    v_mul_f32 v64, v64, v20
    v_mul_f32 v65, v65, v20
    v_mfma_f32_32x32x16_bf16 v[96:111], v[216:219], v[16:19], v[96:111]
    v_mul_f32 v66, v66, v20
    v_mul_f32 v67, v67, v20
    v_mul_f32 v68, v68, v20
    v_mul_f32 v69, v69, v20
    v_mul_f32 v70, v70, v20
    v_mfma_f32_32x32x16_bf16 v[112:127], v[220:223], v[16:19], v[112:127]
    v_mul_f32 v71, v71, v20
    v_cvt_pk_bf16_f32 v4, v64, v65
    v_cvt_pk_bf16_f32 v5, v66, v67
    v_cvt_pk_bf16_f32 v6, v68, v69
    v_cvt_pk_bf16_f32 v7, v70, v71
    s_waitcnt lgkmcnt(0)
    s_waitcnt vmcnt(1)
    v_mfma_f32_32x32x16_bf16 v[64:79], v[8:11], v[56:59], 0
    v_add_f32 v20, s64, v88
    v_rcp_f32 v20, v20
    ds_read_b128 v[12:15], v22 offset:8160
    v_mul_f32 v80, v80, v20
    v_mul_f32 v81, v81, v20
    v_mfma_f32_32x32x16_bf16 v[96:111], v[224:227], v[4:7], v[96:111]
    v_mul_f32 v82, v82, v20
    v_mul_f32 v83, v83, v20
    v_mul_f32 v84, v84, v20
    v_mul_f32 v85, v85, v20
    v_mul_f32 v86, v86, v20
    v_mfma_f32_32x32x16_bf16 v[112:127], v[228:231], v[4:7], v[112:127]
    v_mul_f32 v87, v87, v20
    v_cvt_pk_bf16_f32 v16, v80, v81
    v_cvt_pk_bf16_f32 v17, v82, v83
    v_cvt_pk_bf16_f32 v18, v84, v85
    v_cvt_pk_bf16_f32 v19, v86, v87
    s_waitcnt lgkmcnt(0)
    s_waitcnt vmcnt(0)
    v_mfma_f32_32x32x16_bf16 v[80:95], v[12:15], v[60:63], 0
    v_add_f32 v20, s64, v72
    v_rcp_f32 v20, v20
    s_nop 0
    v_mul_f32 v64, v64, v20
    v_mul_f32 v65, v65, v20
    v_mfma_f32_32x32x16_bf16 v[96:111], v[232:235], v[16:19], v[96:111]
    v_mul_f32 v66, v66, v20
    v_mul_f32 v67, v67, v20
    v_mul_f32 v68, v68, v20
    v_mul_f32 v69, v69, v20
    v_mul_f32 v70, v70, v20
    v_mfma_f32_32x32x16_bf16 v[112:127], v[236:239], v[16:19], v[112:127]
    v_mul_f32 v71, v71, v20
    v_cvt_pk_bf16_f32 v4, v64, v65
    v_cvt_pk_bf16_f32 v5, v66, v67
    v_cvt_pk_bf16_f32 v6, v68, v69
    v_cvt_pk_bf16_f32 v7, v70, v71
    v_add_f32 v20, s64, v88
    v_rcp_f32 v20, v20
    s_nop 0
    v_mul_f32 v80, v80, v20
    v_mul_f32 v81, v81, v20
    v_mfma_f32_32x32x16_bf16 v[96:111], v[240:243], v[4:7], v[96:111]
    v_mul_f32 v82, v82, v20
    v_mul_f32 v83, v83, v20
    v_mul_f32 v84, v84, v20
    v_mul_f32 v85, v85, v20
    v_mul_f32 v86, v86, v20
    v_mfma_f32_32x32x16_bf16 v[112:127], v[244:247], v[4:7], v[112:127]
    v_mul_f32 v87, v87, v20
    v_cvt_pk_bf16_f32 v16, v80, v81
    v_cvt_pk_bf16_f32 v17, v82, v83
    v_cvt_pk_bf16_f32 v18, v84, v85
    v_cvt_pk_bf16_f32 v19, v86, v87
    s_nop 1
    v_mfma_f32_32x32x16_bf16 v[96:111], v[248:251], v[16:19], v[96:111]
    v_mfma_f32_32x32x16_bf16 v[112:127], v[252:255], v[16:19], v[112:127]
    s_cmp_lg_u32 s3, 0
    s_cbranch_scc1 L_b_norst
    s_cmp_lg_u32 s39, 0
    s_cbranch_scc1 L_b_norst
    v_mov_b32 v20, 0
    s_mov_b64 exec, 1
    global_store_dword v20, v20, s[34:35] sc1
    s_mov_b64 exec, -1
L_b_norst:
    s_nop 8
    ds_write_b128 v24, v[96:99] offset:0
    ds_write_b128 v24, v[100:103] offset:32
    ds_write_b128 v24, v[104:107] offset:64
    ds_write_b128 v24, v[108:111] offset:96
    ds_write_b128 v24, v[112:115] offset:128
    ds_write_b128 v24, v[116:119] offset:160
    ds_write_b128 v24, v[120:123] offset:192
    ds_write_b128 v24, v[124:127] offset:224
    s_waitcnt lgkmcnt(0)
    s_barrier
    ds_read_b128 v[32:35], v25 offset:0
    ds_read_b128 v[40:43], v25 offset:17408
    ds_read_b128 v[36:39], v25 offset:16
    ds_read_b128 v[44:47], v25 offset:17424
    ds_read_b128 v[48:51], v25 offset:8704
    ds_read_b128 v[56:59], v25 offset:26112
    ds_read_b128 v[52:55], v25 offset:8720
    ds_read_b128 v[60:63], v25 offset:26128
    s_waitcnt lgkmcnt(4)
    v_add_f32 v32, v32, v40
    v_add_f32 v33, v33, v41
    v_add_f32 v34, v34, v42
    v_add_f32 v35, v35, v43
    v_add_f32 v36, v36, v44
    v_add_f32 v37, v37, v45
    v_add_f32 v38, v38, v46
    v_add_f32 v39, v39, v47
    v_cvt_pk_bf16_f32 v64, v32, v33
    v_cvt_pk_bf16_f32 v65, v34, v35
    v_cvt_pk_bf16_f32 v66, v36, v37
    v_cvt_pk_bf16_f32 v67, v38, v39
    global_store_dwordx4 v26, v[64:67], s[32:33] sc1
    s_waitcnt lgkmcnt(0)
    v_add_f32 v48, v48, v56
    v_add_f32 v49, v49, v57
    v_add_f32 v50, v50, v58
    v_add_f32 v51, v51, v59
    v_add_f32 v52, v52, v60
    v_add_f32 v53, v53, v61
    v_add_f32 v54, v54, v62
    v_add_f32 v55, v55, v63
    v_cvt_pk_bf16_f32 v68, v48, v49
    v_cvt_pk_bf16_f32 v69, v50, v51
    v_cvt_pk_bf16_f32 v70, v52, v53
    v_cvt_pk_bf16_f32 v71, v54, v55
    global_store_dwordx4 v27, v[68:71], s[32:33] sc1
    s_branch L_end
L_roleA:
    s_and_b32 s40, s3, 7
    s_lshr_b32 s41, s3, 3
    s_waitcnt lgkmcnt(0)
    s_lshr_b32 s47, s39, 1
    s_and_b32 s48, s39, 1
    s_lshl_b32 s49, s40, 6
    s_lshl_b32 s50, s41, 1
    s_add_u32 s50, s50, s49
    s_add_u32 s51, s50, s47
    s_lshl_b32 s51, s51, 8
    v_and_b32 v2, 127, v0
    v_lshl_add_u32 v5, v2, 1, s51
    v_lshrrev_b32 v3, 4, v0
    v_and_b32 v4, 15, v0
    s_lshl_b32 s52, s41, 6
    v_lshl_add_u32 v6, v3, 2, s52
    v_lshlrev_b32 v6, 10, v6
    s_lshl_b32 s53, s49, 1
    v_lshl_add_u32 v7, v4, 3, s53
    v_add_u32 v6, v6, v7
    s_lshl_b32 s45, s40, 2
    s_add_u32 s45, s45, 4
    v_mov_b32 v8, s45
    s_waitcnt lgkmcnt(0)
    v_mov_b32 v202, v6
    v_mov_b32 v203, v7
    global_load_ushort v10, v5, s[10:11]
    global_load_ushort v11, v5, s[12:13]
    global_load_ushort v12, v5, s[14:15]
    global_load_ushort v13, v5, s[16:17]
    global_load_ushort v14, v5, s[18:19]
    global_load_ushort v15, v5, s[20:21]
    s_lshl_b32 s54, s50, 1
    s_add_u32 s54, s22, s54
    s_addc_u32 s55, s23, 0
    s_load_dword s56, s[54:55], 0
    s_cmp_lg_u32 s41, 0
    s_cbranch_scc1 L_a_nopub
    s_cmp_lg_u32 s39, 0
    s_cbranch_scc1 L_a_nopub
    s_memrealtime s[58:59]
    s_waitcnt lgkmcnt(0)
    s_or_b32 s58, s58, 8
    v_mov_b32 v9, s58
    s_mov_b64 exec, 1
    global_store_dword v8, v9, s[34:35] sc1
    s_mov_b64 exec, -1
L_a_nopub:
    v_and_b32 v26, 15, v1
    v_lshrrev_b32 v27, 4, v1
    v_bfe_u32 v28, v1, 2, 2
    v_and_b32 v29, 3, v1
    v_and_b32 v30, 31, v1
    v_lshrrev_b32 v31, 5, v1
    v_lshlrev_b32 v32, 2, v4
    v_mul_u32_u24 v32, 144, v32
    v_lshlrev_b32 v33, 3, v3
    v_sub_u32 v33, 120, v33
    v_add_u32 v32, v32, v33
    v_add_u32 v160, 3088, v32
    v_lshrrev_b32 v32, 3, v1
    s_lshl_b32 s57, s39, 5
    v_add_u32 v32, s57, v32
    v_mul_u32_u24 v33, 144, v32
    v_and_b32 v34, 7, v1
    v_lshl_add_u32 v33, v34, 4, v33
    v_add_u32 v161, 3088, v33
    v_add_u32 v32, s49, v32
    v_lshlrev_b32 v32, 12, v32
    v_lshl_add_u32 v32, v34, 4, v32
    s_sub_u32 s57, 31, s41
    s_lshl_b32 s57, s57, 7
    s_add_u32 s57, s57, 0
    v_add_u32 v162, s57, v32
    v_add_u32 v163, 32768, v162
    v_add_u32 v200, 65536, v162
    v_add_u32 v201, 98304, v162
    v_lshl_add_u32 v32, v27, 3, v28
    s_lshl_b32 s59, s47, 15
    s_add_u32 s59, s59, 12288
    v_and_b32 v33, 1, v2
    v_bfe_u32 v34, v2, 2, 1
    v_lshl_add_u32 v33, v34, 1, v33
    v_lshl_add_u32 v34, v2, 8, s59
    v_xor_b32 v35, 0, v33
    v_lshl_add_u32 v164, v35, 5, v34
    v_xor_b32 v35, 1, v33
    v_lshl_add_u32 v165, v35, 5, v34
    v_xor_b32 v35, 2, v33
    v_lshl_add_u32 v166, v35, 5, v34
    v_xor_b32 v35, 3, v33
    v_lshl_add_u32 v167, v35, 5, v34
    v_lshlrev_b32 v34, 7, v32
    v_lshl_add_u32 v34, v29, 3, v34
    v_add_u32 v34, s59, v34
    v_lshrrev_b32 v33, 1, v28
    v_and_b32 v35, 1, v27
    v_lshl_add_u32 v33, v35, 1, v33
    v_xor_b32 v35, 0, v33
    v_lshl_add_u32 v168, v35, 5, v34
    v_xor_b32 v35, 1, v33
    v_lshl_add_u32 v169, v35, 5, v34
    v_xor_b32 v35, 2, v33
    v_lshl_add_u32 v170, v35, 5, v34
    v_xor_b32 v35, 3, v33
    v_lshl_add_u32 v171, v35, 5, v34
    s_mul_i32 s59, s47, 1536
    s_add_u32 s59, s59, 0
    v_lshrrev_b32 v33, 1, v27
    v_lshlrev_b32 v33, 7, v33
    v_lshl_add_u32 v33, v26, 3, v33
    v_and_b32 v34, 1, v27
    v_lshl_add_u32 v33, v34, 2, v33
    v_lshl_add_u32 v172, v33, 1, s59
    v_lshlrev_b32 v33, 6, v27
    v_cmp_gt_u32 vcc, 2, v27
    v_lshlrev_b32 v34, 2, v26
    v_lshlrev_b32 v35, 1, v26
    v_cndmask_b32 v34, v35, v34, vcc
    v_add_u32 v33, v33, v34
    v_add_u32 v33, 256, v33
    v_mov_b32 v34, 32
    v_mov_b32 v35, 2
    v_cndmask_b32 v34, v34, v35, vcc
    v_add_u32 v34, v33, v34
    v_lshl_add_u32 v173, v33, 1, s59
    v_lshl_add_u32 v174, v34, 1, s59
    v_lshl_add_u32 v33, v27, 6, v26
    v_add_u32 v33, 512, v33
    v_lshl_add_u32 v175, v33, 1, s59
    v_lshlrev_b32 v33, 4, v0
    v_add_u32 v176, 16, v33
    v_mov_b32 v177, v33
    v_lshlrev_b32 v34, 3, v0
    v_add_u32 v178, 256, v34
    s_cmp_eq_u32 s39, 1
    s_cbranch_scc0 L_a_ad1
    v_lshlrev_b32 v34, 2, v0
    v_add_u32 v177, 512, v34
L_a_ad1:
    s_cmp_ge_u32 s39, 2
    s_cbranch_scc0 L_a_ad2
    v_add_u32 v34, 384, v0
    v_lshlrev_b32 v177, 1, v34
L_a_ad2:
    v_mov_b32 v179, v33
    v_lshrrev_b32 v34, 2, v0
    v_mul_u32_u24 v34, 4160, v34
    v_and_b32 v35, 3, v0
    v_lshl_add_u32 v180, v35, 4, v34
    v_mul_u32_u24 v34, 4112, v0
    v_add_u32 v181, 3088, v34
    v_mov_b32 v182, v33
    v_add_u32 v183, 64, v33
    v_lshrrev_b32 v34, 7, v0
    v_add_u32 v35, s50, v34
    v_lshlrev_b32 v35, 12, v35
    v_lshl_add_u32 v35, v2, 4, v35
    v_add_u32 v184, 0, v35
    v_lshrrev_b32 v35, 2, v2
    v_mul_u32_u24 v35, 80, v35
    v_and_b32 v36, 3, v2
    v_lshl_add_u32 v35, v36, 4, v35
    v_mul_u32_u24 v34, 7600, v34
    v_add_u32 v185, v35, v34
    v_lshrrev_b32 v34, 3, v1
    v_lshlrev_b32 v34, 7, v34
    v_and_b32 v35, 7, v1
    v_lshl_add_u32 v34, v35, 2, v34
    s_lshl_b32 s58, s40, 10
    s_add_u32 s58, s58, 12648448
    v_add_u32 v186, s58, v34
    v_lshrrev_b32 v34, 3, v30
    v_lshlrev_b32 v34, 7, v34
    v_lshl_add_u32 v34, v35, 2, v34
    s_lshl_b32 s58, s40, 9
    s_add_u32 s58, s58, 12681216
    v_add_u32 v187, s58, v34
    s_lshl_b32 s57, s41, 1
    s_add_u32 s57, s57, s48
    s_lshr_b32 s59, s57, 3
    s_lshl_b32 s59, s59, 7
    s_and_b32 s57, s57, 7
    s_lshl_b32 s57, s57, 2
    s_add_u32 s57, s57, s59
    s_lshl_b32 s59, s40, 10
    s_add_u32 s57, s57, s59
    s_add_u32 s57, s57, 12648448
    v_mov_b32 v188, s57
    s_lshr_b32 s59, s41, 3
    s_lshl_b32 s59, s59, 7
    s_and_b32 s57, s41, 7
    s_lshl_b32 s57, s57, 2
    s_add_u32 s57, s57, s59
    s_add_u32 s57, s57, s58
    v_mov_b32 v189, s57
    v_sub_u32 v34, 3, v30
    v_and_b32 v34, 3, v34
    v_mul_u32_u24 v35, 4160, v34
    v_add_u32 v36, v30, v34
    v_add_u32 v36, 9, v36
    v_lshlrev_b32 v37, 3, v31
    v_sub_u32 v36, v36, v37
    v_lshl_add_u32 v35, v36, 1, v35
    s_mul_i32 s57, s47, 16640
    s_lshl_b32 s58, s48, 10
    s_add_u32 s57, s57, s58
    s_add_u32 s57, s57, 12288
    v_add_u32 v190, s57, v35
    v_sub_u32 v35, 31, v30
    v_mul_u32_u24 v35, 80, v35
    v_lshlrev_b32 v36, 4, v31
    v_sub_u32 v35, v35, v36
    v_add_u32 v35, 16, v35
    s_mul_i32 s57, s47, 7600
    s_mul_i32 s58, s48, 1280
    s_add_u32 s57, s57, s58
    s_add_u32 s57, s57, 45568
    v_add_u32 v191, s57, v35
    v_mul_u32_u24 v35, 144, v30
    v_lshl_add_u32 v35, v31, 4, v35
    s_mul_i32 s57, s39, 9216
    v_add_u32 v192, s57, v35
    v_lshrrev_b32 v35, 2, v0
    v_mul_u32_u24 v35, 144, v35
    v_and_b32 v36, 3, v0
    v_lshl_add_u32 v193, v36, 5, v35
    s_lshl_b32 s57, s50, 12
    s_add_u32 s57, s57, 4194304
    v_lshl_add_u32 v194, v0, 4, s57
    v_lshlrev_b32 v35, 2, v4
    v_add_u32 v35, s49, v35
    v_lshlrev_b32 v35, 12, v35
    v_lshl_add_u32 v35, v3, 3, v35
    s_lshl_b32 s59, s41, 7
    s_add_u32 s59, s59, 4194304
    v_add_u32 v195, s59, v35
    v_add_u32 v196, 4096, v195
    v_add_u32 v197, 8192, v195
    v_add_u32 v198, 12288, v195
    v_lshlrev_b32 v35, 1, v6
    v_sub_u32 v199, v35, v7
    s_lshr_b32 s62, s40, 1
    s_and_b32 s63, s40, 1
    s_lshl_b32 s64, s62, 9
    s_lshl_b32 s65, s41, 4
    s_add_u32 s64, s64, s65
    v_and_b32 v246, 15, v1
    v_lshrrev_b32 v247, 4, v1
    v_add_u32 v241, s64, v246
    v_lshlrev_b32 v241, 10, v241
    v_lshl_add_u32 v241, v247, 7, v241
    v_add_u32 v241, 512, v241
    v_and_b32 v248, 3, v1
    v_lshlrev_b32 v248, 7, v248
    s_lshl_b32 s66, s63, 9
    v_lshrrev_b32 v249, 2, v1
    v_add_u32 v240, s65, v249
    v_mul_u32_u24 v242, 3072, v240
    v_add3_u32 v242, v242, v248, s66
    v_add_u32 v244, 0, v242
    v_lshlrev_b32 v245, 10, v240
    v_add3_u32 v245, v245, v248, s66
    v_and_b32 v249, 7, v249
    s_lshl_b32 s67, s41, 3
    s_add_u32 s67, s67, 256
    v_add_u32 v249, s67, v249
    v_mul_u32_u24 v243, 3072, v249
    v_add3_u32 v243, v243, v248, s66
    v_add_u32 v240, 2048, v242
    v_add_u32 v243, 1024, v243
    s_waitcnt vmcnt(0) lgkmcnt(0)
    s_setprio 1
    global_load_dwordx2 v[16:17], v202, s[8:9]
    global_load_dwordx2 v[18:19], v202, s[8:9] offset:1024
    global_load_dwordx2 v[20:21], v202, s[8:9] offset:2048
    global_load_dwordx2 v[22:23], v202, s[8:9] offset:3072
    global_load_dwordx2 v[24:25], v203, s[24:25]
    s_cmp_eq_u32 s39, 3
    s_cbranch_scc0 L_a_nopt
    global_load_dword v253, v186, s[36:37] sc1
    global_load_dword v254, v187, s[36:37] sc1
L_a_nopt:
    s_cmp_eq_u32 s39, 2
    s_cbranch_scc0 L_tch_3
    global_load_dword v250, v241, s[26:27]
L_tch_3:
    s_cmp_eq_u32 s39, 3
    s_cbranch_scc0 L_tch_4
    global_load_dword v250, v243, s[28:29]
L_tch_4:
    s_lshr_b32 s59, s56, 16
    s_and_b32 s60, s56, 0xffff
    s_cmp_eq_u32 s47, 0
    s_cselect_b32 s59, s60, s59
    s_lshl_b32 s59, s59, 16
    v_mov_b32 v28, s59
    v_mul_f32 v29, 0x3fb8aa3b, v28
    v_mov_b32 v30, 0x3fb8aa3b
    v_fma_f32 v30, v28, v30, -v29
    v_fmac_f32 v30, 0x32a57060, v28
    v_exp_f32 v29, v29
    v_mul_f32 v30, 0x3f317218, v30
    v_fma_f32 v29, v29, v30, v29
    v_cvt_pk_bf16_f32 v29, v29, v29
    v_lshlrev_b32 v29, 16, v29
    v_lshlrev_b32 v10, 16, v10
    v_lshlrev_b32 v11, 16, v11
    v_lshlrev_b32 v12, 16, v12
    v_lshlrev_b32 v13, 16, v13
    v_lshlrev_b32 v14, 16, v14
    v_lshlrev_b32 v15, 16, v15
    v_mul_f32 v10, v29, v10
    v_mul_f32 v11, v29, v11
    v_mul_f32 v12, v29, v12
    v_mul_f32 v13, v29, v13
    v_mul_f32 v10, 0x3fb8aa3b, v10
    v_mul_f32 v11, 0x3e22f983, v11
    v_pk_mul_f32 v[28:29], v[14:15], v[12:13] op_sel_hi:[1,0]
    v_pk_fma_f32 v[50:51], v[14:15], v[12:13], v[28:29] op_sel:[1,1,0] op_sel_hi:[0,1,1] neg_lo:[1,0,0]
    v_exp_f32 v6, v10
    v_fract_f32 v7, v11
    v_cos_f32 v26, v7
    v_sin_f32 v27, v7
    v_mul_f32 v52, v6, v26
    v_mul_f32 v53, v6, v27
    v_mul_f32 v6, 0x41000000, v10
    v_mul_f32 v7, 0x41000000, v11
    v_exp_f32 v6, v6
    v_fract_f32 v7, v7
    v_cos_f32 v26, v7
    v_sin_f32 v27, v7
    v_mul_f32 v54, v6, v26
    v_mul_f32 v55, v6, v27
    v_mul_f32 v6, 0x43000000, v10
    v_mul_f32 v7, 0x43000000, v11
    v_exp_f32 v6, v6
    v_fract_f32 v7, v7
    v_cos_f32 v26, v7
    v_sin_f32 v27, v7
    v_mul_f32 v56, v6, v26
    v_mul_f32 v57, v6, v27
    v_mul_f32 v6, 0x43800000, v10
    v_mul_f32 v7, 0x43800000, v11
    v_exp_f32 v6, v6
    v_fract_f32 v7, v7
    v_cos_f32 v26, v7
    v_sin_f32 v27, v7
    v_mul_f32 v58, v6, v26
    v_mul_f32 v59, v6, v27
    v_mul_f32 v6, 0x44000000, v10
    v_mul_f32 v7, 0x44000000, v11
    v_exp_f32 v6, v6
    v_fract_f32 v7, v7
    v_cos_f32 v26, v7
    v_sin_f32 v27, v7
    v_mul_f32 v60, v6, v26
    v_mul_f32 v61, v6, v27
    v_mul_f32 v6, 0x44800000, v10
    v_mul_f32 v7, 0x44800000, v11
    v_exp_f32 v6, v6
    v_fract_f32 v7, v7
    v_cos_f32 v26, v7
    v_sin_f32 v27, v7
    v_mul_f32 v62, v6, v26
    v_mul_f32 v63, v6, v27
    v_mov_b32 v64, 1.0
    v_mov_b32 v65, 0
    v_pk_mul_f32 v[28:29], v[50:51], v[52:53] op_sel_hi:[1,0]
    v_pk_fma_f32 v[82:83], v[50:51], v[52:53], v[28:29] op_sel:[1,1,0] op_sel_hi:[0,1,1] neg_lo:[1,0,0]
    v_pk_mul_f32 v[30:31], v[82:83], v[52:53] op_sel_hi:[1,0]
    v_pk_fma_f32 v[84:85], v[82:83], v[52:53], v[30:31] op_sel:[1,1,0] op_sel_hi:[0,1,1] neg_lo:[1,0,0]
    v_pk_mul_f32 v[28:29], v[84:85], v[52:53] op_sel_hi:[1,0]
    v_pk_fma_f32 v[86:87], v[84:85], v[52:53], v[28:29] op_sel:[1,1,0] op_sel_hi:[0,1,1] neg_lo:[1,0,0]
    v_pk_mul_f32 v[30:31], v[86:87], v[52:53] op_sel_hi:[1,0]
    v_pk_fma_f32 v[88:89], v[86:87], v[52:53], v[30:31] op_sel:[1,1,0] op_sel_hi:[0,1,1] neg_lo:[1,0,0]
    v_pk_mul_f32 v[28:29], v[88:89], v[52:53] op_sel_hi:[1,0]
    v_pk_fma_f32 v[90:91], v[88:89], v[52:53], v[28:29] op_sel:[1,1,0] op_sel_hi:[0,1,1] neg_lo:[1,0,0]
    v_pk_mul_f32 v[30:31], v[90:91], v[52:53] op_sel_hi:[1,0]
    v_pk_fma_f32 v[92:93], v[90:91], v[52:53], v[30:31] op_sel:[1,1,0] op_sel_hi:[0,1,1] neg_lo:[1,0,0]
    v_pk_mul_f32 v[28:29], v[92:93], v[52:53] op_sel_hi:[1,0]
    v_pk_fma_f32 v[94:95], v[92:93], v[52:53], v[28:29] op_sel:[1,1,0] op_sel_hi:[0,1,1] neg_lo:[1,0,0]
    v_cvt_pk_bf16_f32 v120, v50, v82
    v_cvt_pk_bf16_f32 v124, -v51, -v83
    v_cvt_pk_bf16_f32 v121, v84, v86
    v_cvt_pk_bf16_f32 v125, -v85, -v87
    v_cvt_pk_bf16_f32 v122, v88, v90
    v_cvt_pk_bf16_f32 v126, -v89, -v91
    v_cvt_pk_bf16_f32 v123, v92, v94
    v_cvt_pk_bf16_f32 v127, -v93, -v95
    ds_write_b128 v164, v[120:123] offset:0
    ds_write_b128 v164, v[124:127] offset:128
    v_pk_mul_f32 v[30:31], v[54:55], v[54:55] op_sel_hi:[1,0]
    v_pk_fma_f32 v[96:97], v[54:55], v[54:55], v[30:31] op_sel:[1,1,0] op_sel_hi:[0,1,1] neg_lo:[1,0,0]
    v_pk_mul_f32 v[28:29], v[96:97], v[54:55] op_sel_hi:[1,0]
    v_pk_fma_f32 v[98:99], v[96:97], v[54:55], v[28:29] op_sel:[1,1,0] op_sel_hi:[0,1,1] neg_lo:[1,0,0]
    v_pk_mul_f32 v[30:31], v[96:97], v[96:97] op_sel_hi:[1,0]
    v_pk_fma_f32 v[100:101], v[96:97], v[96:97], v[30:31] op_sel:[1,1,0] op_sel_hi:[0,1,1] neg_lo:[1,0,0]
    v_pk_mul_f32 v[28:29], v[100:101], v[54:55] op_sel_hi:[1,0]
    v_pk_fma_f32 v[102:103], v[100:101], v[54:55], v[28:29] op_sel:[1,1,0] op_sel_hi:[0,1,1] neg_lo:[1,0,0]
    v_pk_mul_f32 v[30:31], v[100:101], v[96:97] op_sel_hi:[1,0]
    v_pk_fma_f32 v[104:105], v[100:101], v[96:97], v[30:31] op_sel:[1,1,0] op_sel_hi:[0,1,1] neg_lo:[1,0,0]
    v_pk_mul_f32 v[28:29], v[100:101], v[98:99] op_sel_hi:[1,0]
    v_pk_fma_f32 v[106:107], v[100:101], v[98:99], v[28:29] op_sel:[1,1,0] op_sel_hi:[0,1,1] neg_lo:[1,0,0]
    v_cvt_pk_bf16_f32 v128, v64, v54
    v_cvt_pk_bf16_f32 v132, v65, v55
    v_cvt_pk_bf16_f32 v129, v96, v98
    v_cvt_pk_bf16_f32 v133, v97, v99
    v_cvt_pk_bf16_f32 v130, v100, v102
    v_cvt_pk_bf16_f32 v134, v101, v103
    v_cvt_pk_bf16_f32 v131, v104, v106
    v_cvt_pk_bf16_f32 v135, v105, v107
    ds_write_b128 v167, v[128:131] offset:0
    ds_write_b128 v167, v[132:135] offset:128
    v_pk_mul_f32 v[30:31], v[100:101], v[100:101] op_sel_hi:[1,0]
    v_pk_fma_f32 v[66:67], v[100:101], v[100:101], v[30:31] op_sel:[1,1,0] op_sel_hi:[0,1,1] neg_lo:[1,0,0]
    v_pk_mul_f32 v[28:29], v[66:67], v[54:55] op_sel_hi:[1,0]
    v_pk_fma_f32 v[68:69], v[66:67], v[54:55], v[28:29] op_sel:[1,1,0] op_sel_hi:[0,1,1] neg_lo:[1,0,0]
    v_pk_mul_f32 v[30:31], v[66:67], v[96:97] op_sel_hi:[1,0]
    v_pk_fma_f32 v[70:71], v[66:67], v[96:97], v[30:31] op_sel:[1,1,0] op_sel_hi:[0,1,1] neg_lo:[1,0,0]
    v_pk_mul_f32 v[28:29], v[66:67], v[98:99] op_sel_hi:[1,0]
    v_pk_fma_f32 v[72:73], v[66:67], v[98:99], v[28:29] op_sel:[1,1,0] op_sel_hi:[0,1,1] neg_lo:[1,0,0]
    v_pk_mul_f32 v[30:31], v[66:67], v[100:101] op_sel_hi:[1,0]
    v_pk_fma_f32 v[74:75], v[66:67], v[100:101], v[30:31] op_sel:[1,1,0] op_sel_hi:[0,1,1] neg_lo:[1,0,0]
    v_pk_mul_f32 v[28:29], v[66:67], v[102:103] op_sel_hi:[1,0]
    v_pk_fma_f32 v[76:77], v[66:67], v[102:103], v[28:29] op_sel:[1,1,0] op_sel_hi:[0,1,1] neg_lo:[1,0,0]
    v_pk_mul_f32 v[30:31], v[66:67], v[104:105] op_sel_hi:[1,0]
    v_pk_fma_f32 v[78:79], v[66:67], v[104:105], v[30:31] op_sel:[1,1,0] op_sel_hi:[0,1,1] neg_lo:[1,0,0]
    v_pk_mul_f32 v[28:29], v[66:67], v[106:107] op_sel_hi:[1,0]
    v_pk_fma_f32 v[80:81], v[66:67], v[106:107], v[28:29] op_sel:[1,1,0] op_sel_hi:[0,1,1] neg_lo:[1,0,0]
    v_cvt_pk_bf16_f32 v120, v66, v68
    v_cvt_pk_bf16_f32 v124, v67, v69
    v_cvt_pk_bf16_f32 v121, v70, v72
    v_cvt_pk_bf16_f32 v125, v71, v73
    v_cvt_pk_bf16_f32 v122, v74, v76
    v_cvt_pk_bf16_f32 v126, v75, v77
    v_cvt_pk_bf16_f32 v123, v78, v80
    v_cvt_pk_bf16_f32 v127, v79, v81
    ds_write_b128 v167, v[120:123] offset:16
    ds_write_b128 v167, v[124:127] offset:144
    v_pk_mul_f32 v[30:31], v[50:51], v[56:57] op_sel_hi:[1,0]
    v_pk_fma_f32 v[66:67], v[50:51], v[56:57], v[30:31] op_sel:[1,1,0] op_sel_hi:[0,1,1] neg_lo:[1,0,0]
    v_pk_mul_f32 v[28:29], v[82:83], v[56:57] op_sel_hi:[1,0]
    v_pk_fma_f32 v[68:69], v[82:83], v[56:57], v[28:29] op_sel:[1,1,0] op_sel_hi:[0,1,1] neg_lo:[1,0,0]
    v_pk_mul_f32 v[30:31], v[84:85], v[56:57] op_sel_hi:[1,0]
    v_pk_fma_f32 v[70:71], v[84:85], v[56:57], v[30:31] op_sel:[1,1,0] op_sel_hi:[0,1,1] neg_lo:[1,0,0]
    v_pk_mul_f32 v[28:29], v[86:87], v[56:57] op_sel_hi:[1,0]
    v_pk_fma_f32 v[72:73], v[86:87], v[56:57], v[28:29] op_sel:[1,1,0] op_sel_hi:[0,1,1] neg_lo:[1,0,0]
    v_pk_mul_f32 v[30:31], v[88:89], v[56:57] op_sel_hi:[1,0]
    v_pk_fma_f32 v[74:75], v[88:89], v[56:57], v[30:31] op_sel:[1,1,0] op_sel_hi:[0,1,1] neg_lo:[1,0,0]
    v_pk_mul_f32 v[28:29], v[90:91], v[56:57] op_sel_hi:[1,0]
    v_pk_fma_f32 v[76:77], v[90:91], v[56:57], v[28:29] op_sel:[1,1,0] op_sel_hi:[0,1,1] neg_lo:[1,0,0]
    v_pk_mul_f32 v[30:31], v[92:93], v[56:57] op_sel_hi:[1,0]
    v_pk_fma_f32 v[78:79], v[92:93], v[56:57], v[30:31] op_sel:[1,1,0] op_sel_hi:[0,1,1] neg_lo:[1,0,0]
    v_pk_mul_f32 v[28:29], v[94:95], v[56:57] op_sel_hi:[1,0]
    v_pk_fma_f32 v[80:81], v[94:95], v[56:57], v[28:29] op_sel:[1,1,0] op_sel_hi:[0,1,1] neg_lo:[1,0,0]
    v_cvt_pk_bf16_f32 v128, v66, v68
    v_cvt_pk_bf16_f32 v132, -v67, -v69
    v_cvt_pk_bf16_f32 v129, v70, v72
    v_cvt_pk_bf16_f32 v133, -v71, -v73
    v_cvt_pk_bf16_f32 v130, v74, v76
    v_cvt_pk_bf16_f32 v134, -v75, -v77
    v_cvt_pk_bf16_f32 v131, v78, v80
    v_cvt_pk_bf16_f32 v135, -v79, -v81
    ds_write_b128 v164, v[128:131] offset:16
    ds_write_b128 v164, v[132:135] offset:144
    s_cmp_eq_u32 s39, 2
    s_cbranch_scc1 L_a_uw2
    s_cmp_eq_u32 s39, 3
    s_cbranch_scc1 L_a_uw3
    s_waitcnt vmcnt(0)
    s_branch L_a_uwd
L_a_uw2:
    s_waitcnt vmcnt(1)
    s_branch L_a_uwd
L_a_uw3:
    s_waitcnt vmcnt(3)
L_a_uwd:
    s_mov_b32 s57, 0x05040100
    s_mov_b32 s58, 0x07060302
    v_perm_b32 v32, v20, v22, s57
    v_perm_b32 v33, v16, v18, s57
    ds_write_b64 v160, v[32:33] offset:0
    v_perm_b32 v34, v20, v22, s58
    v_perm_b32 v35, v16, v18, s58
    ds_write_b64 v160, v[34:35] offset:144
    v_perm_b32 v36, v21, v23, s57
    v_perm_b32 v37, v17, v19, s57
    ds_write_b64 v160, v[36:37] offset:288
    v_perm_b32 v38, v21, v23, s58
    v_perm_b32 v39, v17, v19, s58
    ds_write_b64 v160, v[38:39] offset:432
    s_waitcnt lgkmcnt(0)
    s_barrier
    s_cmp_ge_u32 s39, 2
    s_cbranch_scc1 L_a_nout
    ds_read_b128 v[224:227], v161 offset:0
    ds_read_b128 v[228:231], v161 offset:1152
    ds_read_b128 v[232:235], v161 offset:2304
    ds_read_b128 v[236:239], v161 offset:3456
    s_waitcnt lgkmcnt(3)
    global_store_dwordx4 v162, v[224:227], s[36:37]
    s_waitcnt lgkmcnt(2)
    global_store_dwordx4 v163, v[228:231], s[36:37]
    s_waitcnt lgkmcnt(1)
    global_store_dwordx4 v200, v[232:235], s[36:37]
    s_waitcnt lgkmcnt(0)
    global_store_dwordx4 v201, v[236:239], s[36:37]
    global_load_dword v9, v8, s[34:35] sc1
L_a_nout:
    v_pk_mul_f32 v[30:31], v[50:51], v[58:59] op_sel_hi:[1,0]
    v_pk_fma_f32 v[66:67], v[50:51], v[58:59], v[30:31] op_sel:[1,1,0] op_sel_hi:[0,1,1] neg_lo:[1,0,0]
    v_pk_mul_f32 v[28:29], v[84:85], v[58:59] op_sel_hi:[1,0]
    v_pk_fma_f32 v[68:69], v[84:85], v[58:59], v[28:29] op_sel:[1,1,0] op_sel_hi:[0,1,1] neg_lo:[1,0,0]
    v_pk_mul_f32 v[30:31], v[88:89], v[58:59] op_sel_hi:[1,0]
    v_pk_fma_f32 v[70:71], v[88:89], v[58:59], v[30:31] op_sel:[1,1,0] op_sel_hi:[0,1,1] neg_lo:[1,0,0]
    v_pk_mul_f32 v[28:29], v[92:93], v[58:59] op_sel_hi:[1,0]
    v_pk_fma_f32 v[72:73], v[92:93], v[58:59], v[28:29] op_sel:[1,1,0] op_sel_hi:[0,1,1] neg_lo:[1,0,0]
    v_pk_mul_f32 v[30:31], v[66:67], v[56:57] op_sel_hi:[1,0]
    v_pk_fma_f32 v[74:75], v[66:67], v[56:57], v[30:31] op_sel:[1,1,0] op_sel_hi:[0,1,1] neg_lo:[1,0,0]
    v_pk_mul_f32 v[28:29], v[68:69], v[56:57] op_sel_hi:[1,0]
    v_pk_fma_f32 v[76:77], v[68:69], v[56:57], v[28:29] op_sel:[1,1,0] op_sel_hi:[0,1,1] neg_lo:[1,0,0]
    v_pk_mul_f32 v[30:31], v[70:71], v[56:57] op_sel_hi:[1,0]
    v_pk_fma_f32 v[78:79], v[70:71], v[56:57], v[30:31] op_sel:[1,1,0] op_sel_hi:[0,1,1] neg_lo:[1,0,0]
    v_pk_mul_f32 v[28:29], v[72:73], v[56:57] op_sel_hi:[1,0]
    v_pk_fma_f32 v[80:81], v[72:73], v[56:57], v[28:29] op_sel:[1,1,0] op_sel_hi:[0,1,1] neg_lo:[1,0,0]
    v_cvt_pk_bf16_f32 v120, v66, v68
    v_cvt_pk_bf16_f32 v124, -v67, -v69
    v_cvt_pk_bf16_f32 v121, v70, v72
    v_cvt_pk_bf16_f32 v125, -v71, -v73
    v_cvt_pk_bf16_f32 v122, v74, v76
    v_cvt_pk_bf16_f32 v126, -v75, -v77
    v_cvt_pk_bf16_f32 v123, v78, v80
    v_cvt_pk_bf16_f32 v127, -v79, -v81
    ds_write_b128 v165, v[120:123] offset:0
    ds_write_b128 v165, v[124:127] offset:128
    v_pk_mul_f32 v[30:31], v[50:51], v[60:61] op_sel_hi:[1,0]
    v_pk_fma_f32 v[66:67], v[50:51], v[60:61], v[30:31] op_sel:[1,1,0] op_sel_hi:[0,1,1] neg_lo:[1,0,0]
    v_pk_mul_f32 v[28:29], v[88:89], v[60:61] op_sel_hi:[1,0]
    v_pk_fma_f32 v[68:69], v[88:89], v[60:61], v[28:29] op_sel:[1,1,0] op_sel_hi:[0,1,1] neg_lo:[1,0,0]
    v_pk_mul_f32 v[30:31], v[66:67], v[56:57] op_sel_hi:[1,0]
    v_pk_fma_f32 v[70:71], v[66:67], v[56:57], v[30:31] op_sel:[1,1,0] op_sel_hi:[0,1,1] neg_lo:[1,0,0]
    v_pk_mul_f32 v[28:29], v[68:69], v[56:57] op_sel_hi:[1,0]
    v_pk_fma_f32 v[72:73], v[68:69], v[56:57], v[28:29] op_sel:[1,1,0] op_sel_hi:[0,1,1] neg_lo:[1,0,0]
    v_pk_mul_f32 v[30:31], v[70:71], v[56:57] op_sel_hi:[1,0]
    v_pk_fma_f32 v[74:75], v[70:71], v[56:57], v[30:31] op_sel:[1,1,0] op_sel_hi:[0,1,1] neg_lo:[1,0,0]
    v_pk_mul_f32 v[28:29], v[72:73], v[56:57] op_sel_hi:[1,0]
    v_pk_fma_f32 v[76:77], v[72:73], v[56:57], v[28:29] op_sel:[1,1,0] op_sel_hi:[0,1,1] neg_lo:[1,0,0]
    v_pk_mul_f32 v[30:31], v[74:75], v[56:57] op_sel_hi:[1,0]
    v_pk_fma_f32 v[78:79], v[74:75], v[56:57], v[30:31] op_sel:[1,1,0] op_sel_hi:[0,1,1] neg_lo:[1,0,0]
    v_pk_mul_f32 v[28:29], v[76:77], v[56:57] op_sel_hi:[1,0]
    v_pk_fma_f32 v[80:81], v[76:77], v[56:57], v[28:29] op_sel:[1,1,0] op_sel_hi:[0,1,1] neg_lo:[1,0,0]
    v_cvt_pk_bf16_f32 v128, v66, v68
    v_cvt_pk_bf16_f32 v132, -v67, -v69
    v_cvt_pk_bf16_f32 v129, v70, v72
    v_cvt_pk_bf16_f32 v133, -v71, -v73
    v_cvt_pk_bf16_f32 v130, v74, v76
    v_cvt_pk_bf16_f32 v134, -v75, -v77
    v_cvt_pk_bf16_f32 v131, v78, v80
    v_cvt_pk_bf16_f32 v135, -v79, -v81
    ds_write_b128 v165, v[128:131] offset:16
    ds_write_b128 v165, v[132:135] offset:144
    v_pk_mul_f32 v[30:31], v[50:51], v[62:63] op_sel_hi:[1,0]
    v_pk_fma_f32 v[66:67], v[50:51], v[62:63], v[30:31] op_sel:[1,1,0] op_sel_hi:[0,1,1] neg_lo:[1,0,0]
    v_pk_mul_f32 v[28:29], v[66:67], v[56:57] op_sel_hi:[1,0]
    v_pk_fma_f32 v[68:69], v[66:67], v[56:57], v[28:29] op_sel:[1,1,0] op_sel_hi:[0,1,1] neg_lo:[1,0,0]
    v_pk_mul_f32 v[30:31], v[68:69], v[56:57] op_sel_hi:[1,0]
    v_pk_fma_f32 v[70:71], v[68:69], v[56:57], v[30:31] op_sel:[1,1,0] op_sel_hi:[0,1,1] neg_lo:[1,0,0]
    v_pk_mul_f32 v[28:29], v[70:71], v[56:57] op_sel_hi:[1,0]
    v_pk_fma_f32 v[72:73], v[70:71], v[56:57], v[28:29] op_sel:[1,1,0] op_sel_hi:[0,1,1] neg_lo:[1,0,0]
    v_pk_mul_f32 v[30:31], v[72:73], v[56:57] op_sel_hi:[1,0]
    v_pk_fma_f32 v[74:75], v[72:73], v[56:57], v[30:31] op_sel:[1,1,0] op_sel_hi:[0,1,1] neg_lo:[1,0,0]
    v_pk_mul_f32 v[28:29], v[74:75], v[56:57] op_sel_hi:[1,0]
    v_pk_fma_f32 v[76:77], v[74:75], v[56:57], v[28:29] op_sel:[1,1,0] op_sel_hi:[0,1,1] neg_lo:[1,0,0]
    v_pk_mul_f32 v[30:31], v[76:77], v[56:57] op_sel_hi:[1,0]
    v_pk_fma_f32 v[78:79], v[76:77], v[56:57], v[30:31] op_sel:[1,1,0] op_sel_hi:[0,1,1] neg_lo:[1,0,0]
    v_pk_mul_f32 v[28:29], v[78:79], v[56:57] op_sel_hi:[1,0]
    v_pk_fma_f32 v[80:81], v[78:79], v[56:57], v[28:29] op_sel:[1,1,0] op_sel_hi:[0,1,1] neg_lo:[1,0,0]
    v_pk_mul_f32 v[30:31], v[66:67], v[62:63] op_sel_hi:[1,0]
    v_pk_fma_f32 v[108:109], v[66:67], v[62:63], v[30:31] op_sel:[1,1,0] op_sel_hi:[0,1,1] neg_lo:[1,0,0]
    v_cvt_pk_bf16_f32 v120, v66, v68
    v_cvt_pk_bf16_f32 v124, -v67, -v69
    v_cvt_pk_bf16_f32 v121, v70, v72
    v_cvt_pk_bf16_f32 v125, -v71, -v73
    v_cvt_pk_bf16_f32 v122, v74, v76
    v_cvt_pk_bf16_f32 v126, -v75, -v77
    v_cvt_pk_bf16_f32 v123, v78, v80
    v_cvt_pk_bf16_f32 v127, -v79, -v81
    ds_write_b128 v166, v[120:123] offset:0
    ds_write_b128 v166, v[124:127] offset:128
    v_cvt_pk_bf16_f32 v120, v108, -v109
    ds_write_b16 v166, v120 offset:16
    ds_write_b16_d16_hi v166, v120 offset:144
    s_cmp_ge_u32 s39, 2
    s_cbranch_scc1 L_a_nofl
    s_mov_b32 s61, 0
    s_waitcnt vmcnt(0)
    v_readfirstlane_b32 s38, v9
    s_nop 0
    s_cmp_lg_u32 s38, 0
    s_cbranch_scc1 L_a_nok
L_a_npoll:
    global_load_dword v9, v8, s[34:35] sc1
    s_waitcnt vmcnt(0)
    v_readfirstlane_b32 s38, v9
    s_add_u32 s61, s61, 1
    s_cmp_gt_u32 s61, 200000
    s_cbranch_scc1 L_a_nok
    s_cmp_eq_u32 s38, 0
    s_cbranch_scc1 L_a_npoll
L_a_nok:
    s_getreg_b32 s57, hwreg(HW_REG_XCC_ID)
    s_and_b32 s57, s57, 7
    s_and_b32 s58, s38, 0xfffffff8
    s_or_b32 s57, s57, s58
    v_mov_b32 v9, s57
    s_mov_b64 exec, 1
    global_store_dword v188, v9, s[36:37]
    s_mov_b64 exec, -1
L_a_nofl:
    s_waitcnt lgkmcnt(0)
    s_barrier
    s_cmp_lg_u32 s39, 0
    s_cbranch_scc1 L_a_uf0
    global_load_dword v30, v186, s[36:37] sc1
L_a_uf0:
    s_cmp_eq_u32 s39, 2
    s_cbranch_scc0 L_tch_5
    global_load_dword v250, v240, s[28:29]
L_tch_5:
    s_cmp_eq_u32 s48, 0
    s_cbranch_scc0 L_a_k2
    ds_read_b64_tr_b16 v[32:33], v171 offset:0
    ds_read_b64_tr_b16 v[34:35], v171 offset:512
    ds_read_b64_tr_b16 v[64:65], v168 offset:0
    ds_read_b64_tr_b16 v[66:67], v168 offset:512
    ds_read_b64_tr_b16 v[96:97], v169 offset:0
    ds_read_b64_tr_b16 v[98:99], v169 offset:512
    ds_read_b64_tr_b16 v[36:37], v171 offset:4096
    ds_read_b64_tr_b16 v[38:39], v171 offset:4608
    ds_read_b64_tr_b16 v[68:69], v168 offset:4096
    ds_read_b64_tr_b16 v[70:71], v168 offset:4608
    ds_read_b64_tr_b16 v[100:101], v169 offset:4096
    ds_read_b64_tr_b16 v[102:103], v169 offset:4608
    ds_read_b64_tr_b16 v[40:41], v171 offset:8192
    ds_read_b64_tr_b16 v[42:43], v171 offset:8704
    ds_read_b64_tr_b16 v[72:73], v168 offset:8192
    ds_read_b64_tr_b16 v[74:75], v168 offset:8704
    ds_read_b64_tr_b16 v[104:105], v169 offset:8192
    ds_read_b64_tr_b16 v[106:107], v169 offset:8704
    ds_read_b64_tr_b16 v[44:45], v171 offset:12288
    ds_read_b64_tr_b16 v[46:47], v171 offset:12800
    ds_read_b64_tr_b16 v[76:77], v168 offset:12288
    ds_read_b64_tr_b16 v[78:79], v168 offset:12800
    ds_read_b64_tr_b16 v[108:109], v169 offset:12288
    ds_read_b64_tr_b16 v[110:111], v169 offset:12800
    ds_read_b64_tr_b16 v[48:49], v171 offset:16384
    ds_read_b64_tr_b16 v[50:51], v171 offset:16896
    ds_read_b64_tr_b16 v[80:81], v168 offset:16384
    ds_read_b64_tr_b16 v[82:83], v168 offset:16896
    ds_read_b64_tr_b16 v[112:113], v169 offset:16384
    ds_read_b64_tr_b16 v[114:115], v169 offset:16896
    ds_read_b64_tr_b16 v[52:53], v171 offset:20480
    ds_read_b64_tr_b16 v[54:55], v171 offset:20992
    ds_read_b64_tr_b16 v[84:85], v168 offset:20480
    ds_read_b64_tr_b16 v[86:87], v168 offset:20992
    ds_read_b64_tr_b16 v[116:117], v169 offset:20480
    ds_read_b64_tr_b16 v[118:119], v169 offset:20992
    ds_read_b64_tr_b16 v[56:57], v171 offset:24576
    ds_read_b64_tr_b16 v[58:59], v171 offset:25088
    ds_read_b64_tr_b16 v[88:89], v168 offset:24576
    ds_read_b64_tr_b16 v[90:91], v168 offset:25088
    ds_read_b64_tr_b16 v[120:121], v169 offset:24576
    ds_read_b64_tr_b16 v[122:123], v169 offset:25088
    ds_read_b64_tr_b16 v[60:61], v171 offset:28672
    ds_read_b64_tr_b16 v[62:63], v171 offset:29184
    ds_read_b64_tr_b16 v[92:93], v168 offset:28672
    ds_read_b64_tr_b16 v[94:95], v168 offset:29184
    ds_read_b64_tr_b16 v[124:125], v169 offset:28672
    ds_read_b64_tr_b16 v[126:127], v169 offset:29184
    s_waitcnt lgkmcnt(15)
    v_mfma_f32_16x16x32_bf16 v[128:131], v[64:67], v[32:35], 0
    v_mfma_f32_16x16x32_bf16 v[132:135], v[96:99], v[32:35], 0
    s_waitcnt lgkmcnt(15)
    v_mfma_f32_16x16x32_bf16 v[128:131], v[68:71], v[36:39], v[128:131]
    v_mfma_f32_16x16x32_bf16 v[132:135], v[100:103], v[36:39], v[132:135]
    s_waitcnt lgkmcnt(15)
    v_mfma_f32_16x16x32_bf16 v[128:131], v[72:75], v[40:43], v[128:131]
    v_mfma_f32_16x16x32_bf16 v[132:135], v[104:107], v[40:43], v[132:135]
    s_waitcnt lgkmcnt(15)
    v_mfma_f32_16x16x32_bf16 v[128:131], v[76:79], v[44:47], v[128:131]
    v_mfma_f32_16x16x32_bf16 v[132:135], v[108:111], v[44:47], v[132:135]
    s_waitcnt lgkmcnt(15)
    v_mfma_f32_16x16x32_bf16 v[128:131], v[80:83], v[48:51], v[128:131]
    v_mfma_f32_16x16x32_bf16 v[132:135], v[112:115], v[48:51], v[132:135]
    s_waitcnt lgkmcnt(12)
    v_mfma_f32_16x16x32_bf16 v[128:131], v[84:87], v[52:55], v[128:131]
    v_mfma_f32_16x16x32_bf16 v[132:135], v[116:119], v[52:55], v[132:135]
    s_waitcnt lgkmcnt(6)
    v_mfma_f32_16x16x32_bf16 v[128:131], v[88:91], v[56:59], v[128:131]
    v_mfma_f32_16x16x32_bf16 v[132:135], v[120:123], v[56:59], v[132:135]
    s_waitcnt lgkmcnt(0)
    v_mfma_f32_16x16x32_bf16 v[128:131], v[92:95], v[60:63], v[128:131]
    v_mfma_f32_16x16x32_bf16 v[132:135], v[124:127], v[60:63], v[132:135]
    s_nop 6
    v_cvt_pk_bf16_f32 v136, v128, v129
    v_cvt_pk_bf16_f32 v137, v130, v131
    v_cvt_pk_bf16_f32 v138, v132, v133
    v_cvt_pk_bf16_f32 v139, v134, v135
    ds_write_b64 v172, v[136:137]
    ds_write_b32 v173, v138
    ds_write_b32 v174, v139
    s_branch L_a_kdone
L_a_k2:
    ds_read_b64_tr_b16 v[32:33], v171 offset:0
    ds_read_b64_tr_b16 v[34:35], v171 offset:512
    ds_read_b64_tr_b16 v[64:65], v170 offset:0
    ds_read_b64_tr_b16 v[66:67], v170 offset:512
    ds_read_b64_tr_b16 v[36:37], v171 offset:4096
    ds_read_b64_tr_b16 v[38:39], v171 offset:4608
    ds_read_b64_tr_b16 v[68:69], v170 offset:4096
    ds_read_b64_tr_b16 v[70:71], v170 offset:4608
    ds_read_b64_tr_b16 v[40:41], v171 offset:8192
    ds_read_b64_tr_b16 v[42:43], v171 offset:8704
    ds_read_b64_tr_b16 v[72:73], v170 offset:8192
    ds_read_b64_tr_b16 v[74:75], v170 offset:8704
    ds_read_b64_tr_b16 v[44:45], v171 offset:12288
    ds_read_b64_tr_b16 v[46:47], v171 offset:12800
    ds_read_b64_tr_b16 v[76:77], v170 offset:12288
    ds_read_b64_tr_b16 v[78:79], v170 offset:12800
    ds_read_b64_tr_b16 v[48:49], v171 offset:16384
    ds_read_b64_tr_b16 v[50:51], v171 offset:16896
    ds_read_b64_tr_b16 v[80:81], v170 offset:16384
    ds_read_b64_tr_b16 v[82:83], v170 offset:16896
    ds_read_b64_tr_b16 v[52:53], v171 offset:20480
    ds_read_b64_tr_b16 v[54:55], v171 offset:20992
    ds_read_b64_tr_b16 v[84:85], v170 offset:20480
    ds_read_b64_tr_b16 v[86:87], v170 offset:20992
    ds_read_b64_tr_b16 v[56:57], v171 offset:24576
    ds_read_b64_tr_b16 v[58:59], v171 offset:25088
    ds_read_b64_tr_b16 v[88:89], v170 offset:24576
    ds_read_b64_tr_b16 v[90:91], v170 offset:25088
    ds_read_b64_tr_b16 v[60:61], v171 offset:28672
    ds_read_b64_tr_b16 v[62:63], v171 offset:29184
    ds_read_b64_tr_b16 v[92:93], v170 offset:28672
    ds_read_b64_tr_b16 v[94:95], v170 offset:29184
    s_waitcnt lgkmcnt(15)
    v_mfma_f32_16x16x32_bf16 v[128:131], v[64:67], v[32:35], 0
    s_waitcnt lgkmcnt(15)
    v_mfma_f32_16x16x32_bf16 v[128:131], v[68:71], v[36:39], v[128:131]
    s_waitcnt lgkmcnt(15)
    v_mfma_f32_16x16x32_bf16 v[128:131], v[72:75], v[40:43], v[128:131]
    s_waitcnt lgkmcnt(15)
    v_mfma_f32_16x16x32_bf16 v[128:131], v[76:79], v[44:47], v[128:131]
    s_waitcnt lgkmcnt(12)
    v_mfma_f32_16x16x32_bf16 v[128:131], v[80:83], v[48:51], v[128:131]
    s_waitcnt lgkmcnt(8)
    v_mfma_f32_16x16x32_bf16 v[128:131], v[84:87], v[52:55], v[128:131]
    s_waitcnt lgkmcnt(4)
    v_mfma_f32_16x16x32_bf16 v[128:131], v[88:91], v[56:59], v[128:131]
    s_waitcnt lgkmcnt(0)
    v_mfma_f32_16x16x32_bf16 v[128:131], v[92:95], v[60:63], v[128:131]
    s_nop 7
    v_cvt_pk_bf16_f32 v136, v128, v129
    v_cvt_pk_bf16_f32 v137, v130, v131
    ds_write_b16 v175, v136
    ds_write_b16_d16_hi v175, v136 offset:32
    ds_write_b16 v175, v137 offset:64
    ds_write_b16_d16_hi v175, v137 offset:96
L_a_kdone:
    s_cmp_lg_u32 s39, 0
    s_cbranch_scc1 L_a_uf1
    s_and_b32 s58, s38, 0xfffffff8
    s_getreg_b32 s57, hwreg(HW_REG_XCC_ID)
    s_and_b32 s57, s57, 7
    s_or_b32 s59, s57, s58
    s_waitcnt vmcnt(0)
    v_cmp_ne_u32 vcc, s59, v30
    s_nop 0
    s_cmp_eq_u64 vcc, 0
    s_cselect_b32 s57, 1, 0
    v_mov_b32 v31, s57
    v_mov_b32 v30, 0
    ds_write_b32 v30, v31 offset:3080
    ds_write_b32 v30, v31 offset:3076
L_a_uf1:
    s_cmp_eq_u32 s39, 3
    s_cbranch_scc0 L_tch_6
    global_load_dword v250, v244, s[28:29]
L_tch_6:
    s_mov_b32 s57, 0x01000100
    s_mov_b32 s58, 0x03020302
    s_mov_b32 s59, 0x05040302
    s_mov_b32 s63, 0x05040100
    v_mov_b32 v48, 0
    v_mov_b32 v49, 0
    v_mov_b32 v50, 0
    v_mov_b32 v51, 0
    s_waitcnt lgkmcnt(0)
    s_barrier
    v_mov_b32 v30, 0
    ds_read_b32 v31, v30 offset:3080
    s_waitcnt lgkmcnt(0)
    v_readfirstlane_b32 s44, v31
    s_nop 0
    s_cmp_eq_u32 s44, 0
    s_cbranch_scc1 L_a_ul0
    global_load_dwordx4 v[208:211], v184, s[36:37] sc1
    global_load_dwordx4 v[212:215], v184, s[36:37] offset:2048 sc1
L_a_ul0:
    s_cmp_eq_u32 s39, 0
    s_cbranch_scc1 L_a_e0
    s_cmp_eq_u32 s39, 1
    s_cbranch_scc1 L_a_e2
    ds_read_u16 v32, v177 offset:0
    ds_read_u16 v33, v177 offset:2
    ds_read_u16 v34, v177 offset:1536
    ds_read_u16 v35, v177 offset:1538
    v_and_b32 v28, 1, v0
    v_cmp_eq_u32 vcc, 0, v28
    s_waitcnt lgkmcnt(0)
    v_perm_b32 v40, v33, v32, s57
    v_perm_b32 v43, v32, v33, s57
    v_perm_b32 v42, v33, v32, s63
    v_mov_b32 v41, v40
    v_cndmask_b32 v42, v43, v42, vcc
    v_perm_b32 v44, v35, v34, s57
    v_perm_b32 v47, v34, v35, s57
    v_perm_b32 v46, v35, v34, s63
    v_mov_b32 v45, v44
    v_cndmask_b32 v46, v47, v46, vcc
    s_branch L_a_ew
L_a_e2:
    ds_read_b32 v32, v177 offset:0
    ds_read_b32 v33, v177 offset:4
    ds_read_b32 v34, v177 offset:1536
    ds_read_b32 v35, v177 offset:1540
    s_waitcnt lgkmcnt(0)
    v_perm_b32 v40, v32, v32, s57
    v_mov_b32 v41, v32
    v_perm_b32 v42, v32, v32, s58
    v_perm_b32 v43, v33, v33, s57
    v_perm_b32 v44, v34, v34, s57
    v_mov_b32 v45, v34
    v_perm_b32 v46, v34, v34, s58
    v_perm_b32 v47, v35, v35, s57
    s_branch L_a_ew
L_a_e0:
    ds_read_b128 v[40:43], v177 offset:0
    ds_read_b64 v[32:33], v178 offset:0
    ds_read_b32 v34, v178 offset:8
    ds_read_b128 v[44:47], v177 offset:1536
    ds_read_b64 v[36:37], v178 offset:1536
    ds_read_b32 v38, v178 offset:1544
    v_cmp_le_u32 vcc, 32, v0
    s_waitcnt lgkmcnt(0)
    v_perm_b32 v52, v32, v32, s57
    v_perm_b32 v53, v33, v32, s59
    v_perm_b32 v54, v33, v33, s57
    v_perm_b32 v55, v34, v33, s59
    v_cndmask_b32 v40, v40, v52, vcc
    v_cndmask_b32 v41, v41, v53, vcc
    v_cndmask_b32 v42, v42, v54, vcc
    v_cndmask_b32 v43, v43, v55, vcc
    v_perm_b32 v52, v36, v36, s57
    v_perm_b32 v53, v37, v36, s59
    v_perm_b32 v54, v37, v37, s57
    v_perm_b32 v55, v38, v37, s59
    v_cndmask_b32 v44, v44, v52, vcc
    v_cndmask_b32 v45, v45, v53, vcc
    v_cndmask_b32 v46, v46, v54, vcc
    v_cndmask_b32 v47, v47, v55, vcc
L_a_ew:
    ds_write_b128 v176, v[40:43] offset:3088
    ds_write_b128 v176, v[44:47] offset:7200
    v_cmp_gt_u32 vcc, 160, v0
    s_nop 0
    s_and_b64 exec, exec, vcc
    ds_write_b128 v179, v[48:51] offset:50688
    ds_write_b128 v179, v[48:51] offset:58288
    v_cmp_gt_u32 vcc, 32, v0
    s_nop 0
    s_and_b64 exec, exec, vcc
    ds_write_b128 v180, v[48:51] offset:12288
    v_cmp_gt_u32 vcc, 2, v0
    s_nop 0
    s_and_b64 exec, exec, vcc
    ds_write_b128 v181, v[48:51]
    s_mov_b64 exec, -1
    s_waitcnt lgkmcnt(0)
    s_barrier
    ds_read_b64 v[32:33], v182 offset:3096
    ds_read_b128 v[36:39], v182 offset:3104
    ds_read_b64 v[48:49], v182 offset:7208
    ds_read_b128 v[52:55], v182 offset:7216
    s_waitcnt lgkmcnt(2)
    ds_write_b128 v183, v[36:39] offset:12288
    v_alignbit_b32 v40, v33, v32, 16
    v_alignbit_b32 v41, v36, v33, 16
    v_alignbit_b32 v42, v37, v36, 16
    v_alignbit_b32 v43, v38, v37, 16
    ds_write_b128 v183, v[40:43] offset:24768
    v_alignbit_b32 v96, v36, v33, 16
    v_alignbit_b32 v97, v37, v36, 16
    v_alignbit_b32 v98, v38, v37, 16
    v_alignbit_b32 v99, v39, v38, 16
    ds_write_b128 v183, v[96:99] offset:16448
    v_mov_b32 v100, v33
    v_mov_b32 v101, v36
    v_mov_b32 v102, v37
    v_mov_b32 v103, v38
    ds_write_b128 v183, v[100:103] offset:20608
    s_waitcnt lgkmcnt(4)
    ds_write_b128 v183, v[52:55] offset:28928
    v_alignbit_b32 v56, v49, v48, 16
    v_alignbit_b32 v57, v52, v49, 16
    v_alignbit_b32 v58, v53, v52, 16
    v_alignbit_b32 v59, v54, v53, 16
    ds_write_b128 v183, v[56:59] offset:41408
    v_alignbit_b32 v104, v52, v49, 16
    v_alignbit_b32 v105, v53, v52, 16
    v_alignbit_b32 v106, v54, v53, 16
    v_alignbit_b32 v107, v55, v54, 16
    ds_write_b128 v183, v[104:107] offset:33088
    v_mov_b32 v108, v49
    v_mov_b32 v109, v52
    v_mov_b32 v110, v53
    v_mov_b32 v111, v54
    ds_write_b128 v183, v[108:111] offset:37248
    s_cmp_lg_u32 s44, 0
    s_cbranch_scc1 L_a_fast
    s_cmp_ge_u32 s39, 2
    s_cbranch_scc1 L_a_utf_go
    s_and_b32 s58, s38, 0xfffffff8
    s_getreg_b32 s57, hwreg(HW_REG_XCC_ID)
    s_and_b32 s57, s57, 7
    s_or_b32 s59, s57, s58
    s_mov_b32 s61, 0
    v_add_u32 v28, 8192, v186
L_a_utf_poll:
    global_load_dword v30, v186, s[36:37] sc1
    global_load_dword v31, v28, s[36:37] sc1
    s_add_u32 s61, s61, 1
    s_waitcnt vmcnt(0)
    v_cmp_ne_u32 vcc, s59, v30
    s_nop 0
    s_cmp_eq_u64 vcc, 0
    s_cbranch_scc1 L_a_utf_local
    v_cmp_ne_u32 s[64:65], s58, v31
    s_nop 0
    s_and_b64 vcc, vcc, s[64:65]
    s_cbranch_vccz L_a_utf_glob
    s_cmp_eq_u32 s61, 200
    s_cbranch_scc0 L_a_utf_again
    s_mov_b32 s60, 0
L_a_utf_pub:
    global_store_dwordx4 v162, v[224:227], s[36:37] sc1
    global_store_dwordx4 v163, v[228:231], s[36:37] sc1
    global_store_dwordx4 v200, v[232:235], s[36:37] sc1
    global_store_dwordx4 v201, v[236:239], s[36:37] sc1
    s_waitcnt vmcnt(0)
    v_add_u32 v29, 8192, v188
    v_mov_b32 v30, s58
    s_mov_b64 exec, 1
    global_store_dword v29, v30, s[36:37] sc1
    s_mov_b64 exec, -1
    s_cmp_lg_u32 s60, 0
    s_cbranch_scc1 L_a_utf_glob2
L_a_utf_again:
    s_cmp_gt_u32 s61, 200000
    s_cbranch_scc1 L_a_utf_glob2
    s_sleep 1
    s_branch L_a_utf_poll
L_a_utf_local:
    s_mov_b32 s57, 1
    s_branch L_a_utf_ok
L_a_utf_glob:
    s_mov_b32 s60, 1
    s_cmp_lt_u32 s61, 200
    s_cbranch_scc1 L_a_utf_pub
    s_cmp_eq_u32 s61, 200
    s_cbranch_scc1 L_a_utf_pub
L_a_utf_glob2:
    s_mov_b32 s57, 0
L_a_utf_ok:
    v_mov_b32 v31, s57
    v_mov_b32 v30, 0
    ds_write_b32 v30, v31 offset:3076
L_a_utf_go:
    s_waitcnt lgkmcnt(0)
    s_barrier
    global_load_dwordx4 v[208:211], v184, s[36:37] sc1
    global_load_dwordx4 v[212:215], v184, s[36:37] offset:2048 sc1
L_a_fast:
    v_mov_b32 v30, 0
    ds_read_b32 v31, v30 offset:3076
    v_lshlrev_b32 v80, 16, v24
    v_and_b32 v81, 0xffff0000, v24
    v_lshlrev_b32 v82, 16, v25
    v_and_b32 v83, 0xffff0000, v25
    v_lshlrev_b32 v96, 16, v16
    v_mul_f32 v96, v96, v80
    v_and_b32 v97, 0xffff0000, v16
    v_mul_f32 v97, v97, v81
    v_lshlrev_b32 v98, 16, v17
    v_mul_f32 v98, v98, v82
    v_and_b32 v99, 0xffff0000, v17
    v_mul_f32 v99, v99, v83
    v_cvt_pk_bf16_f32 v84, v96, v97
    v_cvt_pk_bf16_f32 v85, v98, v99
    v_lshlrev_b32 v96, 16, v84
    v_and_b32 v97, 0xffff0000, v84
    v_lshlrev_b32 v98, 16, v85
    v_and_b32 v99, 0xffff0000, v85
    v_lshlrev_b32 v100, 16, v18
    v_mul_f32 v100, v100, v80
    v_and_b32 v101, 0xffff0000, v18
    v_mul_f32 v101, v101, v81
    v_lshlrev_b32 v102, 16, v19
    v_mul_f32 v102, v102, v82
    v_and_b32 v103, 0xffff0000, v19
    v_mul_f32 v103, v103, v83
    v_cvt_pk_bf16_f32 v84, v100, v101
    v_cvt_pk_bf16_f32 v85, v102, v103
    v_lshlrev_b32 v100, 16, v84
    v_and_b32 v101, 0xffff0000, v84
    v_lshlrev_b32 v102, 16, v85
    v_and_b32 v103, 0xffff0000, v85
    v_lshlrev_b32 v104, 16, v20
    v_mul_f32 v104, v104, v80
    v_and_b32 v105, 0xffff0000, v20
    v_mul_f32 v105, v105, v81
    v_lshlrev_b32 v106, 16, v21
    v_mul_f32 v106, v106, v82
    v_and_b32 v107, 0xffff0000, v21
    v_mul_f32 v107, v107, v83
    v_cvt_pk_bf16_f32 v84, v104, v105
    v_cvt_pk_bf16_f32 v85, v106, v107
    v_lshlrev_b32 v104, 16, v84
    v_and_b32 v105, 0xffff0000, v84
    v_lshlrev_b32 v106, 16, v85
    v_and_b32 v107, 0xffff0000, v85
    v_lshlrev_b32 v108, 16, v22
    v_mul_f32 v108, v108, v80
    v_and_b32 v109, 0xffff0000, v22
    v_mul_f32 v109, v109, v81
    v_lshlrev_b32 v110, 16, v23
    v_mul_f32 v110, v110, v82
    v_and_b32 v111, 0xffff0000, v23
    v_mul_f32 v111, v111, v83
    v_cvt_pk_bf16_f32 v84, v108, v109
    v_cvt_pk_bf16_f32 v85, v110, v111
    v_lshlrev_b32 v108, 16, v84
    v_and_b32 v109, 0xffff0000, v84
    v_lshlrev_b32 v110, 16, v85
    v_and_b32 v111, 0xffff0000, v85
    s_waitcnt vmcnt(0) lgkmcnt(0)
    v_readfirstlane_b32 s46, v31
    ds_write_b128 v185, v[208:211] offset:45568
    ds_write_b128 v185, v[212:215] offset:48128
    s_waitcnt lgkmcnt(0)
    s_barrier
    s_setprio 0
    s_cmp_eq_u32 s39, 3
    s_cbranch_scc0 L_tch_7
    global_load_dword v250, v245, s[30:31]
L_tch_7:
    s_cmp_lg_u32 s39, 2
    s_cbranch_scc1 L_a_noyt
    s_lshl_b32 s57, s50, 12
    s_add_u32 s57, s57, 4194304
    v_lshl_add_u32 v28, v1, 7, s57
    global_load_dword v252, v28, s[36:37]
L_a_noyt:
    ds_read_b64 v[32:33], v190 offset:32
    ds_read_b64 v[34:35], v190 offset:40
    ds_read_b128 v[40:43], v191 offset:2592
    ds_read_b128 v[44:47], v191 offset:32
    ds_read_b64 v[36:37], v190 offset:2080
    ds_read_b64 v[38:39], v190 offset:2088
    ds_read_b64 v[48:49], v190 offset:0
    ds_read_b64 v[50:51], v190 offset:8
    ds_read_b128 v[56:59], v191 offset:2560
    ds_read_b128 v[60:63], v191 offset:0
    ds_read_b64 v[52:53], v190 offset:2048
    ds_read_b64 v[54:55], v190 offset:2056
    s_waitcnt lgkmcnt(6)
    v_mfma_f32_32x32x16_bf16 v[128:143], v[32:35], v[40:43], 0
    ds_read_b64 v[64:65], v190 offset:96
    ds_read_b64 v[66:67], v190 offset:104
    v_mfma_f32_32x32x16_bf16 v[144:159], v[32:35], v[44:47], 0
    ds_read_b128 v[72:75], v191 offset:2672
    ds_read_b128 v[76:79], v191 offset:112
    v_mfma_f32_32x32x16_bf16 v[144:159], v[36:39], v[40:43], v[144:159]
    ds_read_b64 v[68:69], v190 offset:2144
    ds_read_b64 v[70:71], v190 offset:2152
    s_waitcnt lgkmcnt(6)
    v_mfma_f32_32x32x16_bf16 v[128:143], v[48:51], v[56:59], v[128:143]
    ds_read_b64 v[32:33], v190 offset:64
    ds_read_b64 v[34:35], v190 offset:72
    v_mfma_f32_32x32x16_bf16 v[144:159], v[48:51], v[60:63], v[144:159]
    ds_read_b128 v[40:43], v191 offset:2640
    ds_read_b128 v[44:47], v191 offset:80
    v_mfma_f32_32x32x16_bf16 v[144:159], v[52:55], v[56:59], v[144:159]
    ds_read_b64 v[36:37], v190 offset:2112
    ds_read_b64 v[38:39], v190 offset:2120
    s_waitcnt lgkmcnt(6)
    v_mfma_f32_32x32x16_bf16 v[128:143], v[64:67], v[72:75], v[128:143]
    ds_read_b64 v[48:49], v190 offset:160
    ds_read_b64 v[50:51], v190 offset:168
    v_mfma_f32_32x32x16_bf16 v[144:159], v[64:67], v[76:79], v[144:159]
    ds_read_b128 v[56:59], v191 offset:2752
    ds_read_b128 v[60:63], v191 offset:192
    v_mfma_f32_32x32x16_bf16 v[144:159], v[68:71], v[72:75], v[144:159]
    ds_read_b64 v[52:53], v190 offset:2208
    ds_read_b64 v[54:55], v190 offset:2216
    s_waitcnt lgkmcnt(6)
    v_mfma_f32_32x32x16_bf16 v[128:143], v[32:35], v[40:43], v[128:143]
    ds_read_b64 v[64:65], v190 offset:128
    ds_read_b64 v[66:67], v190 offset:136
    v_mfma_f32_32x32x16_bf16 v[144:159], v[32:35], v[44:47], v[144:159]
    ds_read_b128 v[72:75], v191 offset:2720
    ds_read_b128 v[76:79], v191 offset:160
    v_mfma_f32_32x32x16_bf16 v[144:159], v[36:39], v[40:43], v[144:159]
    ds_read_b64 v[68:69], v190 offset:2176
    ds_read_b64 v[70:71], v190 offset:2184
    s_waitcnt lgkmcnt(6)
    v_mfma_f32_32x32x16_bf16 v[128:143], v[48:51], v[56:59], v[128:143]
    ds_read_b64 v[32:33], v190 offset:224
    ds_read_b64 v[34:35], v190 offset:232
    v_mfma_f32_32x32x16_bf16 v[144:159], v[48:51], v[60:63], v[144:159]
    ds_read_b128 v[40:43], v191 offset:2832
    ds_read_b128 v[44:47], v191 offset:272
    v_mfma_f32_32x32x16_bf16 v[144:159], v[52:55], v[56:59], v[144:159]
    ds_read_b64 v[36:37], v190 offset:2272
    ds_read_b64 v[38:39], v190 offset:2280
    s_waitcnt lgkmcnt(6)
    v_mfma_f32_32x32x16_bf16 v[128:143], v[64:67], v[72:75], v[128:143]
    ds_read_b64 v[48:49], v190 offset:192
    ds_read_b64 v[50:51], v190 offset:200
    v_mfma_f32_32x32x16_bf16 v[144:159], v[64:67], v[76:79], v[144:159]
    ds_read_b128 v[56:59], v191 offset:2800
    ds_read_b128 v[60:63], v191 offset:240
    v_mfma_f32_32x32x16_bf16 v[144:159], v[68:71], v[72:75], v[144:159]
    ds_read_b64 v[52:53], v190 offset:2240
    ds_read_b64 v[54:55], v190 offset:2248
    s_waitcnt lgkmcnt(6)
    v_mfma_f32_32x32x16_bf16 v[128:143], v[32:35], v[40:43], v[128:143]
    ds_read_b64 v[64:65], v190 offset:288
    ds_read_b64 v[66:67], v190 offset:296
    v_mfma_f32_32x32x16_bf16 v[144:159], v[32:35], v[44:47], v[144:159]
    ds_read_b128 v[72:75], v191 offset:2912
    ds_read_b128 v[76:79], v191 offset:352
    v_mfma_f32_32x32x16_bf16 v[144:159], v[36:39], v[40:43], v[144:159]
    ds_read_b64 v[68:69], v190 offset:2336
    ds_read_b64 v[70:71], v190 offset:2344
    s_waitcnt lgkmcnt(6)
    v_mfma_f32_32x32x16_bf16 v[128:143], v[48:51], v[56:59], v[128:143]
    ds_read_b64 v[32:33], v190 offset:256
    ds_read_b64 v[34:35], v190 offset:264
    v_mfma_f32_32x32x16_bf16 v[144:159], v[48:51], v[60:63], v[144:159]
    ds_read_b128 v[40:43], v191 offset:2880
    ds_read_b128 v[44:47], v191 offset:320
    v_mfma_f32_32x32x16_bf16 v[144:159], v[52:55], v[56:59], v[144:159]
    ds_read_b64 v[36:37], v190 offset:2304
    ds_read_b64 v[38:39], v190 offset:2312
    s_waitcnt lgkmcnt(6)
    v_mfma_f32_32x32x16_bf16 v[128:143], v[64:67], v[72:75], v[128:143]
    ds_read_b64 v[48:49], v190 offset:352
    ds_read_b64 v[50:51], v190 offset:360
    v_mfma_f32_32x32x16_bf16 v[144:159], v[64:67], v[76:79], v[144:159]
    ds_read_b128 v[56:59], v191 offset:2992
    ds_read_b128 v[60:63], v191 offset:432
    v_mfma_f32_32x32x16_bf16 v[144:159], v[68:71], v[72:75], v[144:159]
    ds_read_b64 v[52:53], v190 offset:2400
    ds_read_b64 v[54:55], v190 offset:2408
    s_waitcnt lgkmcnt(6)
    v_mfma_f32_32x32x16_bf16 v[128:143], v[32:35], v[40:43], v[128:143]
    ds_read_b64 v[64:65], v190 offset:320
    ds_read_b64 v[66:67], v190 offset:328
    v_mfma_f32_32x32x16_bf16 v[144:159], v[32:35], v[44:47], v[144:159]
    ds_read_b128 v[72:75], v191 offset:2960
    ds_read_b128 v[76:79], v191 offset:400
    v_mfma_f32_32x32x16_bf16 v[144:159], v[36:39], v[40:43], v[144:159]
    ds_read_b64 v[68:69], v190 offset:2368
    ds_read_b64 v[70:71], v190 offset:2376
    s_waitcnt lgkmcnt(6)
    v_mfma_f32_32x32x16_bf16 v[128:143], v[48:51], v[56:59], v[128:143]
    ds_read_b64 v[32:33], v190 offset:416
    ds_read_b64 v[34:35], v190 offset:424
    v_mfma_f32_32x32x16_bf16 v[144:159], v[48:51], v[60:63], v[144:159]
    ds_read_b128 v[40:43], v191 offset:3072
    ds_read_b128 v[44:47], v191 offset:512
    v_mfma_f32_32x32x16_bf16 v[144:159], v[52:55], v[56:59], v[144:159]
    ds_read_b64 v[36:37], v190 offset:2464
    ds_read_b64 v[38:39], v190 offset:2472
    s_waitcnt lgkmcnt(6)
    v_mfma_f32_32x32x16_bf16 v[128:143], v[64:67], v[72:75], v[128:143]
    ds_read_b64 v[48:49], v190 offset:384
    ds_read_b64 v[50:51], v190 offset:392
    v_mfma_f32_32x32x16_bf16 v[144:159], v[64:67], v[76:79], v[144:159]
    ds_read_b128 v[56:59], v191 offset:3040
    ds_read_b128 v[60:63], v191 offset:480
    v_mfma_f32_32x32x16_bf16 v[144:159], v[68:71], v[72:75], v[144:159]
    ds_read_b64 v[52:53], v190 offset:2432
    ds_read_b64 v[54:55], v190 offset:2440
    s_waitcnt lgkmcnt(6)
    v_mfma_f32_32x32x16_bf16 v[128:143], v[32:35], v[40:43], v[128:143]
    ds_read_b64 v[64:65], v190 offset:480
    ds_read_b64 v[66:67], v190 offset:488
    v_mfma_f32_32x32x16_bf16 v[144:159], v[32:35], v[44:47], v[144:159]
    ds_read_b128 v[72:75], v191 offset:3152
    ds_read_b128 v[76:79], v191 offset:592
    v_mfma_f32_32x32x16_bf16 v[144:159], v[36:39], v[40:43], v[144:159]
    ds_read_b64 v[68:69], v190 offset:2528
    ds_read_b64 v[70:71], v190 offset:2536
    s_waitcnt lgkmcnt(6)
    v_mfma_f32_32x32x16_bf16 v[128:143], v[48:51], v[56:59], v[128:143]
    ds_read_b64 v[32:33], v190 offset:448
    ds_read_b64 v[34:35], v190 offset:456
    v_mfma_f32_32x32x16_bf16 v[144:159], v[48:51], v[60:63], v[144:159]
    ds_read_b128 v[40:43], v191 offset:3120
    ds_read_b128 v[44:47], v191 offset:560
    v_mfma_f32_32x32x16_bf16 v[144:159], v[52:55], v[56:59], v[144:159]
    ds_read_b64 v[36:37], v190 offset:2496
    ds_read_b64 v[38:39], v190 offset:2504
    s_waitcnt lgkmcnt(6)
    v_mfma_f32_32x32x16_bf16 v[128:143], v[64:67], v[72:75], v[128:143]
    ds_read_b64 v[48:49], v190 offset:544
    ds_read_b64 v[50:51], v190 offset:552
    v_mfma_f32_32x32x16_bf16 v[144:159], v[64:67], v[76:79], v[144:159]
    ds_read_b128 v[56:59], v191 offset:3232
    ds_read_b128 v[60:63], v191 offset:672
    v_mfma_f32_32x32x16_bf16 v[144:159], v[68:71], v[72:75], v[144:159]
    ds_read_b64 v[52:53], v190 offset:2592
    ds_read_b64 v[54:55], v190 offset:2600
    s_waitcnt lgkmcnt(6)
    v_mfma_f32_32x32x16_bf16 v[128:143], v[32:35], v[40:43], v[128:143]
    ds_read_b64 v[64:65], v190 offset:512
    ds_read_b64 v[66:67], v190 offset:520
    v_mfma_f32_32x32x16_bf16 v[144:159], v[32:35], v[44:47], v[144:159]
    ds_read_b128 v[72:75], v191 offset:3200
    ds_read_b128 v[76:79], v191 offset:640
    v_mfma_f32_32x32x16_bf16 v[144:159], v[36:39], v[40:43], v[144:159]
    ds_read_b64 v[68:69], v190 offset:2560
    ds_read_b64 v[70:71], v190 offset:2568
    s_waitcnt lgkmcnt(6)
    v_mfma_f32_32x32x16_bf16 v[128:143], v[48:51], v[56:59], v[128:143]
    ds_read_b64 v[32:33], v190 offset:608
    ds_read_b64 v[34:35], v190 offset:616
    v_mfma_f32_32x32x16_bf16 v[144:159], v[48:51], v[60:63], v[144:159]
    ds_read_b128 v[40:43], v191 offset:3312
    ds_read_b128 v[44:47], v191 offset:752
    v_mfma_f32_32x32x16_bf16 v[144:159], v[52:55], v[56:59], v[144:159]
    ds_read_b64 v[36:37], v190 offset:2656
    ds_read_b64 v[38:39], v190 offset:2664
    s_waitcnt lgkmcnt(6)
    v_mfma_f32_32x32x16_bf16 v[128:143], v[64:67], v[72:75], v[128:143]
    ds_read_b64 v[48:49], v190 offset:576
    ds_read_b64 v[50:51], v190 offset:584
    v_mfma_f32_32x32x16_bf16 v[144:159], v[64:67], v[76:79], v[144:159]
    ds_read_b128 v[56:59], v191 offset:3280
    ds_read_b128 v[60:63], v191 offset:720
    v_mfma_f32_32x32x16_bf16 v[144:159], v[68:71], v[72:75], v[144:159]
    ds_read_b64 v[52:53], v190 offset:2624
    ds_read_b64 v[54:55], v190 offset:2632
    s_waitcnt lgkmcnt(6)
    v_mfma_f32_32x32x16_bf16 v[128:143], v[32:35], v[40:43], v[128:143]
    ds_read_b64 v[64:65], v190 offset:672
    ds_read_b64 v[66:67], v190 offset:680
    v_mfma_f32_32x32x16_bf16 v[144:159], v[32:35], v[44:47], v[144:159]
    ds_read_b128 v[72:75], v191 offset:3392
    ds_read_b128 v[76:79], v191 offset:832
    v_mfma_f32_32x32x16_bf16 v[144:159], v[36:39], v[40:43], v[144:159]
    ds_read_b64 v[68:69], v190 offset:2720
    ds_read_b64 v[70:71], v190 offset:2728
    s_waitcnt lgkmcnt(6)
    v_mfma_f32_32x32x16_bf16 v[128:143], v[48:51], v[56:59], v[128:143]
    ds_read_b64 v[32:33], v190 offset:640
    ds_read_b64 v[34:35], v190 offset:648
    v_mfma_f32_32x32x16_bf16 v[144:159], v[48:51], v[60:63], v[144:159]
    ds_read_b128 v[40:43], v191 offset:3360
    ds_read_b128 v[44:47], v191 offset:800
    v_mfma_f32_32x32x16_bf16 v[144:159], v[52:55], v[56:59], v[144:159]
    ds_read_b64 v[36:37], v190 offset:2688
    ds_read_b64 v[38:39], v190 offset:2696
    s_waitcnt lgkmcnt(6)
    v_mfma_f32_32x32x16_bf16 v[128:143], v[64:67], v[72:75], v[128:143]
    ds_read_b64 v[48:49], v190 offset:736
    ds_read_b64 v[50:51], v190 offset:744
    v_mfma_f32_32x32x16_bf16 v[144:159], v[64:67], v[76:79], v[144:159]
    ds_read_b128 v[56:59], v191 offset:3472
    ds_read_b128 v[60:63], v191 offset:912
    v_mfma_f32_32x32x16_bf16 v[144:159], v[68:71], v[72:75], v[144:159]
    ds_read_b64 v[52:53], v190 offset:2784
    ds_read_b64 v[54:55], v190 offset:2792
    s_waitcnt lgkmcnt(6)
    v_mfma_f32_32x32x16_bf16 v[128:143], v[32:35], v[40:43], v[128:143]
    ds_read_b64 v[64:65], v190 offset:704
    ds_read_b64 v[66:67], v190 offset:712
    v_mfma_f32_32x32x16_bf16 v[144:159], v[32:35], v[44:47], v[144:159]
    ds_read_b128 v[72:75], v191 offset:3440
    ds_read_b128 v[76:79], v191 offset:880
    v_mfma_f32_32x32x16_bf16 v[144:159], v[36:39], v[40:43], v[144:159]
    ds_read_b64 v[68:69], v190 offset:2752
    ds_read_b64 v[70:71], v190 offset:2760
    s_waitcnt lgkmcnt(6)
    v_mfma_f32_32x32x16_bf16 v[128:143], v[48:51], v[56:59], v[128:143]
    ds_read_b64 v[32:33], v190 offset:800
    ds_read_b64 v[34:35], v190 offset:808
    v_mfma_f32_32x32x16_bf16 v[144:159], v[48:51], v[60:63], v[144:159]
    ds_read_b128 v[40:43], v191 offset:3552
    ds_read_b128 v[44:47], v191 offset:992
    v_mfma_f32_32x32x16_bf16 v[144:159], v[52:55], v[56:59], v[144:159]
    ds_read_b64 v[36:37], v190 offset:2848
    ds_read_b64 v[38:39], v190 offset:2856
    s_waitcnt lgkmcnt(6)
    v_mfma_f32_32x32x16_bf16 v[128:143], v[64:67], v[72:75], v[128:143]
    ds_read_b64 v[48:49], v190 offset:768
    ds_read_b64 v[50:51], v190 offset:776
    v_mfma_f32_32x32x16_bf16 v[144:159], v[64:67], v[76:79], v[144:159]
    ds_read_b128 v[56:59], v191 offset:3520
    ds_read_b128 v[60:63], v191 offset:960
    v_mfma_f32_32x32x16_bf16 v[144:159], v[68:71], v[72:75], v[144:159]
    ds_read_b64 v[52:53], v190 offset:2816
    ds_read_b64 v[54:55], v190 offset:2824
    s_waitcnt lgkmcnt(6)
    v_mfma_f32_32x32x16_bf16 v[128:143], v[32:35], v[40:43], v[128:143]
    ds_read_b64 v[64:65], v190 offset:864
    ds_read_b64 v[66:67], v190 offset:872
    v_mfma_f32_32x32x16_bf16 v[144:159], v[32:35], v[44:47], v[144:159]
    ds_read_b128 v[72:75], v191 offset:3632
    ds_read_b128 v[76:79], v191 offset:1072
    v_mfma_f32_32x32x16_bf16 v[144:159], v[36:39], v[40:43], v[144:159]
    ds_read_b64 v[68:69], v190 offset:2912
    ds_read_b64 v[70:71], v190 offset:2920
    s_waitcnt lgkmcnt(6)
    v_mfma_f32_32x32x16_bf16 v[128:143], v[48:51], v[56:59], v[128:143]
    ds_read_b64 v[32:33], v190 offset:832
    ds_read_b64 v[34:35], v190 offset:840
    v_mfma_f32_32x32x16_bf16 v[144:159], v[48:51], v[60:63], v[144:159]
    ds_read_b128 v[40:43], v191 offset:3600
    ds_read_b128 v[44:47], v191 offset:1040
    v_mfma_f32_32x32x16_bf16 v[144:159], v[52:55], v[56:59], v[144:159]
    ds_read_b64 v[36:37], v190 offset:2880
    ds_read_b64 v[38:39], v190 offset:2888
    s_waitcnt lgkmcnt(6)
    v_mfma_f32_32x32x16_bf16 v[128:143], v[64:67], v[72:75], v[128:143]
    ds_read_b64 v[48:49], v190 offset:928
    ds_read_b64 v[50:51], v190 offset:936
    v_mfma_f32_32x32x16_bf16 v[144:159], v[64:67], v[76:79], v[144:159]
    ds_read_b128 v[56:59], v191 offset:3712
    ds_read_b128 v[60:63], v191 offset:1152
    v_mfma_f32_32x32x16_bf16 v[144:159], v[68:71], v[72:75], v[144:159]
    ds_read_b64 v[52:53], v190 offset:2976
    ds_read_b64 v[54:55], v190 offset:2984
    s_waitcnt lgkmcnt(6)
    v_mfma_f32_32x32x16_bf16 v[128:143], v[32:35], v[40:43], v[128:143]
    ds_read_b64 v[64:65], v190 offset:896
    ds_read_b64 v[66:67], v190 offset:904
    v_mfma_f32_32x32x16_bf16 v[144:159], v[32:35], v[44:47], v[144:159]
    ds_read_b128 v[72:75], v191 offset:3680
    ds_read_b128 v[76:79], v191 offset:1120
    v_mfma_f32_32x32x16_bf16 v[144:159], v[36:39], v[40:43], v[144:159]
    ds_read_b64 v[68:69], v190 offset:2944
    ds_read_b64 v[70:71], v190 offset:2952
    s_waitcnt lgkmcnt(6)
    v_mfma_f32_32x32x16_bf16 v[128:143], v[48:51], v[56:59], v[128:143]
    ds_read_b64 v[32:33], v190 offset:992
    ds_read_b64 v[34:35], v190 offset:1000
    v_mfma_f32_32x32x16_bf16 v[144:159], v[48:51], v[60:63], v[144:159]
    ds_read_b128 v[40:43], v191 offset:3792
    ds_read_b128 v[44:47], v191 offset:1232
    v_mfma_f32_32x32x16_bf16 v[144:159], v[52:55], v[56:59], v[144:159]
    ds_read_b64 v[36:37], v190 offset:3040
    ds_read_b64 v[38:39], v190 offset:3048
    s_waitcnt lgkmcnt(6)
    v_mfma_f32_32x32x16_bf16 v[128:143], v[64:67], v[72:75], v[128:143]
    ds_read_b64 v[48:49], v190 offset:960
    ds_read_b64 v[50:51], v190 offset:968
    v_mfma_f32_32x32x16_bf16 v[144:159], v[64:67], v[76:79], v[144:159]
    ds_read_b128 v[56:59], v191 offset:3760
    ds_read_b128 v[60:63], v191 offset:1200
    v_mfma_f32_32x32x16_bf16 v[144:159], v[68:71], v[72:75], v[144:159]
    ds_read_b64 v[52:53], v190 offset:3008
    ds_read_b64 v[54:55], v190 offset:3016
    s_waitcnt lgkmcnt(6)
    v_mfma_f32_32x32x16_bf16 v[128:143], v[32:35], v[40:43], v[128:143]
    v_mfma_f32_32x32x16_bf16 v[144:159], v[32:35], v[44:47], v[144:159]
    v_mfma_f32_32x32x16_bf16 v[144:159], v[36:39], v[40:43], v[144:159]
    s_waitcnt lgkmcnt(0)
    v_mfma_f32_32x32x16_bf16 v[128:143], v[48:51], v[56:59], v[128:143]
    v_mfma_f32_32x32x16_bf16 v[144:159], v[48:51], v[60:63], v[144:159]
    v_mfma_f32_32x32x16_bf16 v[144:159], v[52:55], v[56:59], v[144:159]
    s_setprio 0
    s_waitcnt vmcnt(0) lgkmcnt(0)
    s_barrier
    s_nop 6
    ds_write_b128 v192, v[128:131] offset:0
    ds_write_b128 v192, v[132:135] offset:32
    ds_write_b128 v192, v[136:139] offset:64
    ds_write_b128 v192, v[140:143] offset:96
    ds_write_b128 v192, v[144:147] offset:4608
    ds_write_b128 v192, v[148:151] offset:4640
    ds_write_b128 v192, v[152:155] offset:4672
    ds_write_b128 v192, v[156:159] offset:4704
    s_waitcnt lgkmcnt(0)
    s_barrier
    ds_read_b128 v[32:35], v193 offset:0
    ds_read_b128 v[40:43], v193 offset:9216
    ds_read_b128 v[36:39], v193 offset:16
    ds_read_b128 v[44:47], v193 offset:9232
    ds_read_b128 v[48:51], v193 offset:18432
    ds_read_b128 v[56:59], v193 offset:27648
    ds_read_b128 v[52:55], v193 offset:18448
    ds_read_b128 v[60:63], v193 offset:27664
    s_waitcnt lgkmcnt(4)
    v_add_f32 v32, v32, v40
    v_add_f32 v33, v33, v41
    v_add_f32 v34, v34, v42
    v_add_f32 v35, v35, v43
    v_add_f32 v36, v36, v44
    v_add_f32 v37, v37, v45
    v_add_f32 v38, v38, v46
    v_add_f32 v39, v39, v47
    v_cvt_pk_bf16_f32 v64, v32, v33
    v_cvt_pk_bf16_f32 v65, v34, v35
    v_cvt_pk_bf16_f32 v66, v36, v37
    v_cvt_pk_bf16_f32 v67, v38, v39
    s_waitcnt lgkmcnt(0)
    v_add_f32 v48, v48, v56
    v_add_f32 v49, v49, v57
    v_add_f32 v50, v50, v58
    v_add_f32 v51, v51, v59
    v_add_f32 v52, v52, v60
    v_add_f32 v53, v53, v61
    v_add_f32 v54, v54, v62
    v_add_f32 v55, v55, v63
    v_cvt_pk_bf16_f32 v68, v48, v49
    v_cvt_pk_bf16_f32 v69, v50, v51
    v_cvt_pk_bf16_f32 v70, v52, v53
    v_cvt_pk_bf16_f32 v71, v54, v55
    v_add_u32 v29, 4096, v194
    s_cmp_eq_u32 s46, 0
    s_cbranch_scc1 L_a_yg
    global_store_dwordx4 v194, v[64:67], s[36:37]
    global_store_dwordx4 v29, v[68:71], s[36:37]
    s_branch L_a_yd
L_a_yg:
    global_store_dwordx4 v194, v[64:67], s[36:37] sc1
    global_store_dwordx4 v29, v[68:71], s[36:37] sc1
L_a_yd:
    s_waitcnt vmcnt(0)
    s_barrier
    s_cmp_lg_u32 s39, 1
    s_cbranch_scc1 L_a_ytf_go
    v_mov_b32 v28, s38
    s_mov_b64 exec, 1
    s_cmp_eq_u32 s46, 0
    s_cbranch_scc1 L_a_yfg
    global_store_dword v189, v28, s[36:37]
    s_branch L_a_yfd
L_a_yfg:
    global_store_dword v189, v28, s[36:37] sc1
L_a_yfd:
    s_mov_b64 exec, -1
    s_mov_b32 s61, 0
L_a_ytf_poll:
    global_load_dword v29, v187, s[36:37] sc1
    s_add_u32 s61, s61, 1
    s_waitcnt vmcnt(0)
    v_cmp_ne_u32 vcc, s38, v29
    s_cmp_gt_u32 s61, 200000
    s_cbranch_scc1 L_a_ytf_go
    s_cbranch_vccz L_a_ytf_go
    s_sleep 1
    s_branch L_a_ytf_poll
L_a_ytf_go:
    s_barrier
    global_load_dwordx2 v[64:65], v195, s[36:37] sc1
    global_load_dwordx2 v[66:67], v196, s[36:37] sc1
    global_load_dwordx2 v[68:69], v197, s[36:37] sc1
    global_load_dwordx2 v[70:71], v198, s[36:37] sc1
    s_waitcnt vmcnt(0)
    v_lshlrev_b32 v84, 16, v64
    v_lshlrev_b32 v85, 16, v66
    v_lshlrev_b32 v86, 16, v68
    v_lshlrev_b32 v87, 16, v70
    v_add_f32 v84, v84, v96
    v_add_f32 v85, v85, v97
    v_add_f32 v86, v86, v98
    v_add_f32 v87, v87, v99
    v_cvt_pk_bf16_f32 v88, v84, v85
    v_cvt_pk_bf16_f32 v89, v86, v87
    v_and_b32 v84, 0xffff0000, v64
    v_and_b32 v85, 0xffff0000, v66
    v_and_b32 v86, 0xffff0000, v68
    v_and_b32 v87, 0xffff0000, v70
    v_add_f32 v84, v84, v100
    v_add_f32 v85, v85, v101
    v_add_f32 v86, v86, v102
    v_add_f32 v87, v87, v103
    v_cvt_pk_bf16_f32 v90, v84, v85
    v_cvt_pk_bf16_f32 v91, v86, v87
    v_lshlrev_b32 v84, 16, v65
    v_lshlrev_b32 v85, 16, v67
    v_lshlrev_b32 v86, 16, v69
    v_lshlrev_b32 v87, 16, v71
    v_add_f32 v84, v84, v104
    v_add_f32 v85, v85, v105
    v_add_f32 v86, v86, v106
    v_add_f32 v87, v87, v107
    v_cvt_pk_bf16_f32 v92, v84, v85
    v_cvt_pk_bf16_f32 v93, v86, v87
    v_and_b32 v84, 0xffff0000, v65
    v_and_b32 v85, 0xffff0000, v67
    v_and_b32 v86, 0xffff0000, v69
    v_and_b32 v87, 0xffff0000, v71
    v_add_f32 v84, v84, v108
    v_add_f32 v85, v85, v109
    v_add_f32 v86, v86, v110
    v_add_f32 v87, v87, v111
    v_cvt_pk_bf16_f32 v94, v84, v85
    v_cvt_pk_bf16_f32 v95, v86, v87
    v_and_b32 v72, 1, v1
    v_cmp_eq_u32 vcc, 0, v72
    v_mov_b32 v73, 4088
    s_nop 0
    v_cndmask_b32 v73, v73, 0, vcc
    v_add_u32 v199, v199, v73
    v_cndmask_b32 v72, v88, v92, vcc
    v_cndmask_b32 v73, v89, v93, vcc
    v_cndmask_b32 v74, v90, v94, vcc
    v_cndmask_b32 v75, v91, v95, vcc
    v_mov_b32_dpp v76, v72 quad_perm:[1,0,3,2] row_mask:0xf bank_mask:0xf
    v_mov_b32_dpp v77, v73 quad_perm:[1,0,3,2] row_mask:0xf bank_mask:0xf
    v_mov_b32_dpp v78, v74 quad_perm:[1,0,3,2] row_mask:0xf bank_mask:0xf
    v_mov_b32_dpp v79, v75 quad_perm:[1,0,3,2] row_mask:0xf bank_mask:0xf
    v_cndmask_b32 v32, v76, v88, vcc
    v_cndmask_b32 v33, v77, v89, vcc
    v_cndmask_b32 v34, v92, v76, vcc
    v_cndmask_b32 v35, v93, v77, vcc
    global_store_dwordx4 v199, v[32:35], s[32:33] offset:0 sc1
    v_cndmask_b32 v36, v78, v90, vcc
    v_cndmask_b32 v37, v79, v91, vcc
    v_cndmask_b32 v38, v94, v78, vcc
    v_cndmask_b32 v39, v95, v79, vcc
    global_store_dwordx4 v199, v[36:39], s[32:33] offset:2048 sc1
    s_cmp_lg_u32 s41, 0
    s_cbranch_scc1 L_a_norst
    s_cmp_lg_u32 s39, 1
    s_cbranch_scc1 L_a_norst
    v_mov_b32 v8, s45
    v_mov_b32 v9, 0
    s_mov_b64 exec, 1
    global_store_dword v8, v9, s[34:35] sc1
    s_mov_b64 exec, -1
L_a_norst:
L_end:
    s_endpgm

.section .rodata,"a"
.p2align 6
.amdhsa_kernel concat_heads__ssm_conv_s4__linear_attn_block__prompt_kernel
  .amdhsa_next_free_vgpr 256
  .amdhsa_next_free_sgpr 102
  .amdhsa_accum_offset 256
  .amdhsa_group_segment_fixed_size 0
  .amdhsa_kernarg_size 120
  .amdhsa_user_sgpr_count 2
  .amdhsa_user_sgpr_kernarg_segment_ptr 1
  .amdhsa_system_sgpr_workgroup_id_x 1
.end_amdhsa_kernel
```
